```python
import torch

def _softmax(x, axis=-1):
    return torch.softmax(x, dim=axis)
def _gelu(x):
    return torch.nn.functional.gelu(x, approximate="tanh")
def _silu(x):
    return torch.nn.functional.silu(x)
def _sigmoid(x):
    return torch.sigmoid(x)
def _layernorm(x, axis=-1, eps=1e-5):
    m = x.mean(dim=axis, keepdim=True)
    v = x.var(dim=axis, keepdim=True, unbiased=False)
    return (x - m) / torch.sqrt(v + eps)
def _scatter_add(tgt, idx, src, axis=0):
    return tgt.clone().index_add_(axis, idx, src)
def _segment_sum(src, seg, n):
    out = torch.zeros((n,) + src.shape[1:], dtype=src.dtype)
    return out.index_add_(0, seg, src)
def _pad(x, pw):
    flat = tuple(v for pair in reversed(pw) for v in pair)
    return torch.nn.functional.pad(x, flat)

kernel_name = 'recurrent_scan__sliding_block_cached__swiglu_ffn__decode'

def setup_inputs():

    _w = (lambda a: (lambda t: t.to(torch.bfloat16) if t.is_floating_point() else t)(torch.as_tensor(a)))
    def _A_setup():
        B, Sq, D = 1, 1, 576
        Hq, Hkv, Sk, Dh = 32, 16, 16384, 128
        assert Hq % Hkv == 0, (Hq, Hkv)
        return {
            "x": _w((lambda *s: torch.randn(*s, dtype=torch.bfloat16) * 0.05)(B, Sq, D)),
            "k_cache": _w((lambda *s: torch.randn(*s, dtype=torch.bfloat16) * 1.6)(B, Hkv, Sk, Dh)),
            "v_cache": _w((lambda *s: torch.randn(*s, dtype=torch.bfloat16) * 0.2)(B, Hkv, Sk, Dh)),
            "wq": _w((lambda *s: torch.randn(*s, dtype=torch.bfloat16) * 1.6)(D, Hq * Dh) * (D ** -0.5)),
            "wo": _w((lambda *s: torch.randn(*s, dtype=torch.bfloat16) * 0.2)(Hq * Dh, D) * ((Hq * Dh) ** -0.5)),
        }
    _A_in = _A_setup()

    def _B_setup():
        B, S, D, F = 1, 1, 576, 4608
        return {
            "x": _w((lambda *s: torch.randn(*s, dtype=torch.bfloat16) * 0.05)(B, S, D)),
            "w_gate": _w((lambda *s: torch.randn(*s, dtype=torch.bfloat16) * 0.1)(D, F)),
            "w_up": _w((lambda *s: torch.randn(*s, dtype=torch.bfloat16) * 0.1)(D, F)),
            "w_down": _w((lambda *s: torch.randn(*s, dtype=torch.bfloat16) * 0.1)(F, D)),
        }
    _B_in = _B_setup()

    return {
        "A_x": _A_in["x"],
        "A_k_cache": _A_in["k_cache"],
        "A_v_cache": _A_in["v_cache"],
        "A_wq": _A_in["wq"],
        "A_wo": _A_in["wo"],
        "B_x": _B_in["x"],
        "B_w_gate": _B_in["w_gate"],
        "B_w_up": _B_in["w_up"],
        "B_w_down": _B_in["w_down"],
    }

def reference(A_x, A_k_cache, A_v_cache, A_wq, A_wo, B_x, B_w_gate, B_w_up, B_w_down):
    def _A_ref(x, k_cache, v_cache, wq, wo):
        B, Sq, D = x.shape
        Hq, Dh = 32, 128
        Hkv, Sk = k_cache.shape[1], k_cache.shape[2]
        W = min(4096, max(256, Sk // 4))
        rep = Hq // Hkv
        q = (lambda x, *d: x.permute(*d))((x @ wq).reshape(B, Sq, Hq, Dh), 0, 2, 1, 3)
        k = (lambda x, n, axis: torch.repeat_interleave(x, n, dim=axis))(k_cache[:, :, Sk - W:, :], rep, axis=1)
        v = (lambda x, n, axis: torch.repeat_interleave(x, n, dim=axis))(v_cache[:, :, Sk - W:, :], rep, axis=1)
        scores = torch.einsum("bhqd,bhkd->bhqk", q, k) * (Dh ** -0.5)
        p = _softmax(scores, axis=-1)
        o = torch.einsum("bhqk,bhkd->bhqd", p, v)
        return (lambda x, *d: x.permute(*d))(o, 0, 2, 1, 3).reshape(B, Sq, Hq * Dh) @ wo

    def _B_ref(x, w_gate, w_up, w_down):
        g = _silu(x @ w_gate)
        u = x @ w_up
        return (g * u) @ w_down

    x = A_x
    xn = _layernorm(x, axis=-1)
    s = _A_ref(xn, A_k_cache, A_v_cache, A_wq, A_wo)
    g = _silu(_B_ref(xn, B_w_gate, B_w_up, B_w_down))
    return x + s * g
```

```asm
; @launch grid=(256,1,1) block=(1024,1,1) lds=47936
.amdgcn_target "amdgcn-amd-amdhsa--gfx950"
.text
.globl recurrent_scan__sliding_block_cached__swiglu_ffn__decode_kernel
.p2align 8
.type recurrent_scan__sliding_block_cached__swiglu_ffn__decode_kernel,@function
recurrent_scan__sliding_block_cached__swiglu_ffn__decode_kernel:
  s_cmp_ge_u32 s2, 256
  s_cbranch_scc1 L_EXIT
  s_load_dwordx16 s[16:31], s[0:1], 0
  s_load_dwordx8 s[32:39], s[0:1], 64
  v_lshrrev_b32 v2, 6, v0
  v_and_b32 v1, 63, v0
  s_lshr_b32 s4, s2, 4
  s_and_b32 s5, s2, 15
  v_readfirstlane_b32 s3, v2
  s_mov_b32 s91, 0x3db504f3
  s_mov_b32 s92, 0x3fb8aa3b
  v_lshrrev_b32 v2, 4, v1
  v_and_b32 v3, 15, v1
  s_waitcnt lgkmcnt(0)
  s_add_u32 s98, s38, 2424832
  s_addc_u32 s99, s39, 0
  s_load_dword s96, s[98:99], 0
  s_mov_b32 s80, s38
  s_and_b32 s81, s39, 0xffff
  s_mov_b32 s82, 268435456
  s_mov_b32 s83, 0x00020000
  s_cmp_lg_u32 s3, 0
  s_cbranch_scc1 ZF_1
  v_mov_b32 v8, 0
  v_mov_b32 v9, 0
  v_mov_b32 v10, 0
  v_mov_b32 v11, 0
  v_mov_b32 v12, 45568
  ds_write_b128 v12, v[8:11]
  ds_write_b128 v12, v[8:11] offset:16
  ds_write_b128 v12, v[8:11] offset:32
  s_waitcnt lgkmcnt(0)
ZF_1:
  s_barrier
  s_cmp_ge_u32 s3, 8
  s_cbranch_scc1 L_AWAVE
  s_setprio 2
  v_lshlrev_b32 v31, 4, v1
  v_lshlrev_b32 v30, 5, v3
  v_lshl_add_u32 v30, v2, 4, v30
  s_cmp_eq_u32 s3, 0
  s_cbranch_scc1 W0_2
  s_cmp_eq_u32 s3, 1
  s_cbranch_scc1 W1_3
  s_sub_u32 s6, s3, 2
  s_and_b32 s7, s2, 1
  s_sub_u32 s8, 5, s7
  s_cmp_lt_u32 s6, s8
  s_cbranch_scc1 GU_4
  s_branch NONE_5
W0_2:
  s_mov_b32 s40, s16
  s_and_b32 s41, s17, 0xffff
  s_mov_b32 s42, 1152
  s_mov_b32 s43, 0x00020000
  buffer_load_dwordx4 v[48:51], v31, s[40:43], 0 offen
  buffer_load_dwordx4 v[52:55], v31, s[40:43], 0 offen offset:1024
  s_mov_b32 s52, s22
  s_and_b32 s53, s23, 0xffff
  s_mov_b32 s54, 4718592
  s_mov_b32 s55, 0x00020000
  v_lshlrev_b32 v4, 13, v2
  v_lshl_add_u32 v4, v3, 4, v4
  s_mul_i32 s6, s5, 294912
  s_lshl_b32 s7, s4, 1
  s_add_u32 s7, s7, s3
  s_lshl_b32 s7, s7, 8
  s_add_u32 s6, s6, s7
  buffer_load_dwordx4 v[56:59], v4, s[52:55], s6 offen nt
  s_add_u32 s6, s6, 32768
  buffer_load_dwordx4 v[60:63], v4, s[52:55], s6 offen nt
  s_add_u32 s6, s6, 32768
  buffer_load_dwordx4 v[64:67], v4, s[52:55], s6 offen nt
  s_add_u32 s6, s6, 32768
  buffer_load_dwordx4 v[68:71], v4, s[52:55], s6 offen nt
  s_add_u32 s6, s6, 32768
  buffer_load_dwordx4 v[72:75], v4, s[52:55], s6 offen nt
  s_add_u32 s6, s6, 32768
  buffer_load_dwordx4 v[76:79], v4, s[52:55], s6 offen nt
  s_add_u32 s6, s6, 32768
  buffer_load_dwordx4 v[80:83], v4, s[52:55], s6 offen nt
  s_add_u32 s6, s6, 32768
  buffer_load_dwordx4 v[84:87], v4, s[52:55], s6 offen nt
  s_add_u32 s6, s6, 32768
  buffer_load_dwordx4 v[88:91], v4, s[52:55], s6 offen nt
  s_mul_i32 s9, s5, 144
  v_mov_b32 v12, 45596
  v_mov_b32 v13, 1
  v_cmp_eq_u32 vcc, 0, v1
  s_and_saveexec_b64 s[84:85], vcc
  ds_add_u32 v12, v13
  s_mov_b64 exec, s[84:85]
  s_mov_b32 s56, s24
  s_and_b32 s57, s25, 0xffff
  s_mov_b32 s58, 4718592
  s_mov_b32 s59, 0x00020000
  s_mov_b32 s68, s32
  s_and_b32 s69, s33, 0xffff
  s_mov_b32 s70, 5308416
  s_mov_b32 s71, 0x00020000
  s_mov_b32 s72, s34
  s_and_b32 s73, s35, 0xffff
  s_mov_b32 s74, 1152
  s_mov_b32 s75, 0x00020000
  s_waitcnt vmcnt(9)
  ds_write_b128 v31, v[48:51] offset:45632
  ds_write_b128 v31, v[52:55] offset:46656
  v_mov_b32 v8, 0
  v_mov_b32 v9, 0
  v_lshlrev_b32 v10, 16, v48
  v_and_b32 v11, 0xffff0000, v48
  v_add_f32 v8, v8, v10
  v_fmac_f32 v9, v10, v10
  v_add_f32 v8, v8, v11
  v_fmac_f32 v9, v11, v11
  v_lshlrev_b32 v10, 16, v49
  v_and_b32 v11, 0xffff0000, v49
  v_add_f32 v8, v8, v10
  v_fmac_f32 v9, v10, v10
  v_add_f32 v8, v8, v11
  v_fmac_f32 v9, v11, v11
  v_lshlrev_b32 v10, 16, v50
  v_and_b32 v11, 0xffff0000, v50
  v_add_f32 v8, v8, v10
  v_fmac_f32 v9, v10, v10
  v_add_f32 v8, v8, v11
  v_fmac_f32 v9, v11, v11
  v_lshlrev_b32 v10, 16, v51
  v_and_b32 v11, 0xffff0000, v51
  v_add_f32 v8, v8, v10
  v_fmac_f32 v9, v10, v10
  v_add_f32 v8, v8, v11
  v_fmac_f32 v9, v11, v11
  v_lshlrev_b32 v10, 16, v52
  v_and_b32 v11, 0xffff0000, v52
  v_add_f32 v8, v8, v10
  v_fmac_f32 v9, v10, v10
  v_add_f32 v8, v8, v11
  v_fmac_f32 v9, v11, v11
  v_lshlrev_b32 v10, 16, v53
  v_and_b32 v11, 0xffff0000, v53
  v_add_f32 v8, v8, v10
  v_fmac_f32 v9, v10, v10
  v_add_f32 v8, v8, v11
  v_fmac_f32 v9, v11, v11
  v_lshlrev_b32 v10, 16, v54
  v_and_b32 v11, 0xffff0000, v54
  v_add_f32 v8, v8, v10
  v_fmac_f32 v9, v10, v10
  v_add_f32 v8, v8, v11
  v_fmac_f32 v9, v11, v11
  v_lshlrev_b32 v10, 16, v55
  v_and_b32 v11, 0xffff0000, v55
  v_add_f32 v8, v8, v10
  v_fmac_f32 v9, v10, v10
  v_add_f32 v8, v8, v11
  v_fmac_f32 v9, v11, v11
  s_nop 1
  v_add_f32_dpp v8, v8, v8 quad_perm:[1,0,3,2] row_mask:0xf bank_mask:0xf
  s_nop 1
  v_add_f32_dpp v8, v8, v8 quad_perm:[2,3,0,1] row_mask:0xf bank_mask:0xf
  s_nop 1
  v_add_f32_dpp v8, v8, v8 row_half_mirror row_mask:0xf bank_mask:0xf
  s_nop 1
  v_add_f32_dpp v8, v8, v8 row_mirror row_mask:0xf bank_mask:0xf
  v_mov_b32 v10, v8
  s_nop 1
  v_permlane16_swap_b32 v8, v10
  s_nop 0
  v_add_f32 v8, v8, v10
  v_mov_b32 v10, v8
  s_nop 1
  v_permlane32_swap_b32 v8, v10
  s_nop 0
  v_add_f32 v8, v8, v10
  s_nop 1
  v_add_f32_dpp v9, v9, v9 quad_perm:[1,0,3,2] row_mask:0xf bank_mask:0xf
  s_nop 1
  v_add_f32_dpp v9, v9, v9 quad_perm:[2,3,0,1] row_mask:0xf bank_mask:0xf
  s_nop 1
  v_add_f32_dpp v9, v9, v9 row_half_mirror row_mask:0xf bank_mask:0xf
  s_nop 1
  v_add_f32_dpp v9, v9, v9 row_mirror row_mask:0xf bank_mask:0xf
  v_mov_b32 v10, v9
  s_nop 1
  v_permlane16_swap_b32 v9, v10
  s_nop 0
  v_add_f32 v9, v9, v10
  v_mov_b32 v10, v9
  s_nop 1
  v_permlane32_swap_b32 v9, v10
  s_nop 0
  v_add_f32 v9, v9, v10
  v_mul_f32 v8, 0x3ae38e39, v8
  v_mul_f32 v9, 0x3ae38e39, v9
  v_fma_f32 v9, -v8, v8, v9
  v_cvt_pk_bf16_f32 v10, v8, v8
  v_lshlrev_b32 v8, 16, v10
  v_cvt_pk_bf16_f32 v10, v9, v9
  v_lshlrev_b32 v9, 16, v10
  v_add_f32 v9, 0x3727c5ac, v9
  v_cvt_pk_bf16_f32 v10, v9, v9
  v_lshlrev_b32 v9, 16, v10
  v_sqrt_f32 v9, v9
  s_nop 0
  v_cvt_pk_bf16_f32 v10, v9, v9
  v_lshlrev_b32 v9, 16, v10
  v_rcp_f32 v9, v9
  s_nop 0
  v_mov_b32 v12, 47680
  ds_write_b64 v12, v[8:9]
  v_mov_b32 v12, 45568
  v_mov_b32 v13, 1
  v_cmp_eq_u32 vcc, 0, v1
  s_and_saveexec_b64 s[84:85], vcc
  ds_add_u32 v12, v13
  s_mov_b64 exec, s[84:85]
  v_and_b32 v8, 7, v1
  v_and_b32 v9, 1, v1
  v_lshlrev_b32 v9, 4, v9
  v_mov_b32 v25, 0xffff
  v_lshlrev_b32 v9, v9, v25
  v_lshrrev_b32 v8, 1, v8
  v_cmp_eq_u32 vcc, 0, v8
  s_nop 1
  v_cndmask_b32 v25, 0, v9, vcc
  v_cmp_eq_u32 vcc, 1, v8
  s_nop 1
  v_cndmask_b32 v26, 0, v9, vcc
  v_cmp_eq_u32 vcc, 2, v8
  s_nop 1
  v_cndmask_b32 v27, 0, v9, vcc
  v_cmp_eq_u32 vcc, 3, v8
  s_nop 1
  v_cndmask_b32 v28, 0, v9, vcc
  s_lshr_b32 s9, s9, 1
  v_lshl_add_u32 v10, v2, 1, s9
  ds_read_u16 v16, v10 offset:45632
  ds_read_u16 v17, v10 offset:45640
  ds_read_u16 v18, v10 offset:45648
  ds_read_u16 v19, v10 offset:45656
  ds_read_u16 v20, v10 offset:45664
  ds_read_u16 v21, v10 offset:45672
  ds_read_u16 v22, v10 offset:45680
  ds_read_u16 v23, v10 offset:45688
  ds_read_u16 v24, v10 offset:45696
  v_mov_b32 v12, 47680
  ds_read_b64 v[8:9], v12
  s_waitcnt lgkmcnt(0)
  s_add_u32 s97, s96, 1
  s_and_b32 s97, s97, 4095
  v_mov_b32 v29, 4095
  v_mov_b32 v7, s97
  v_lshlrev_b32 v16, 16, v16
  v_sub_f32 v16, v16, v8
  v_cvt_pk_bf16_f32 v16, v16, v16
  v_lshlrev_b32 v16, 16, v16
  v_mul_f32 v16, v16, v9
  v_cvt_pk_bf16_f32 v16, v16, v16
  v_lshlrev_b32 v17, 16, v17
  v_sub_f32 v17, v17, v8
  v_cvt_pk_bf16_f32 v17, v17, v17
  v_lshlrev_b32 v17, 16, v17
  v_mul_f32 v17, v17, v9
  v_cvt_pk_bf16_f32 v17, v17, v17
  v_lshlrev_b32 v18, 16, v18
  v_sub_f32 v18, v18, v8
  v_cvt_pk_bf16_f32 v18, v18, v18
  v_lshlrev_b32 v18, 16, v18
  v_mul_f32 v18, v18, v9
  v_cvt_pk_bf16_f32 v18, v18, v18
  v_lshlrev_b32 v19, 16, v19
  v_sub_f32 v19, v19, v8
  v_cvt_pk_bf16_f32 v19, v19, v19
  v_lshlrev_b32 v19, 16, v19
  v_mul_f32 v19, v19, v9
  v_cvt_pk_bf16_f32 v19, v19, v19
  v_lshlrev_b32 v20, 16, v20
  v_sub_f32 v20, v20, v8
  v_cvt_pk_bf16_f32 v20, v20, v20
  v_lshlrev_b32 v20, 16, v20
  v_mul_f32 v20, v20, v9
  v_cvt_pk_bf16_f32 v20, v20, v20
  v_lshlrev_b32 v21, 16, v21
  v_sub_f32 v21, v21, v8
  v_cvt_pk_bf16_f32 v21, v21, v21
  v_lshlrev_b32 v21, 16, v21
  v_mul_f32 v21, v21, v9
  v_cvt_pk_bf16_f32 v21, v21, v21
  v_lshlrev_b32 v22, 16, v22
  v_sub_f32 v22, v22, v8
  v_cvt_pk_bf16_f32 v22, v22, v22
  v_lshlrev_b32 v22, 16, v22
  v_mul_f32 v22, v22, v9
  v_cvt_pk_bf16_f32 v22, v22, v22
  v_lshlrev_b32 v23, 16, v23
  v_sub_f32 v23, v23, v8
  v_cvt_pk_bf16_f32 v23, v23, v23
  v_lshlrev_b32 v23, 16, v23
  v_mul_f32 v23, v23, v9
  v_cvt_pk_bf16_f32 v23, v23, v23
  v_lshlrev_b32 v24, 16, v24
  v_sub_f32 v24, v24, v8
  v_cvt_pk_bf16_f32 v24, v24, v24
  v_lshlrev_b32 v24, 16, v24
  v_mul_f32 v24, v24, v9
  v_cvt_pk_bf16_f32 v24, v24, v24
  s_waitcnt vmcnt(0)
  v_and_b32 v32, v16, v25
  v_and_b32 v33, v16, v26
  v_and_b32 v34, v16, v27
  v_and_b32 v35, v16, v28
  v_and_b32 v36, v17, v25
  v_and_b32 v37, v17, v26
  v_and_b32 v38, v17, v27
  v_and_b32 v39, v17, v28
  v_mfma_f32_16x16x32_bf16 v[40:43], v[32:35], v[56:59], 0
  v_and_b32 v32, v18, v25
  v_and_b32 v33, v18, v26
  v_and_b32 v34, v18, v27
  v_and_b32 v35, v18, v28
  v_mfma_f32_16x16x32_bf16 v[40:43], v[36:39], v[60:63], v[40:43]
  v_and_b32 v36, v19, v25
  v_and_b32 v37, v19, v26
  v_and_b32 v38, v19, v27
  v_and_b32 v39, v19, v28
  v_mfma_f32_16x16x32_bf16 v[40:43], v[32:35], v[64:67], v[40:43]
  v_and_b32 v32, v20, v25
  v_and_b32 v33, v20, v26
  v_and_b32 v34, v20, v27
  v_and_b32 v35, v20, v28
  v_mfma_f32_16x16x32_bf16 v[40:43], v[36:39], v[68:71], v[40:43]
  v_and_b32 v36, v21, v25
  v_and_b32 v37, v21, v26
  v_and_b32 v38, v21, v27
  v_and_b32 v39, v21, v28
  v_mfma_f32_16x16x32_bf16 v[40:43], v[32:35], v[72:75], v[40:43]
  v_and_b32 v32, v22, v25
  v_and_b32 v33, v22, v26
  v_and_b32 v34, v22, v27
  v_and_b32 v35, v22, v28
  v_mfma_f32_16x16x32_bf16 v[40:43], v[36:39], v[76:79], v[40:43]
  v_and_b32 v36, v23, v25
  v_and_b32 v37, v23, v26
  v_and_b32 v38, v23, v27
  v_and_b32 v39, v23, v28
  v_mfma_f32_16x16x32_bf16 v[40:43], v[32:35], v[80:83], v[40:43]
  v_and_b32 v32, v24, v25
  v_and_b32 v33, v24, v26
  v_and_b32 v34, v24, v27
  v_and_b32 v35, v24, v28
  v_mfma_f32_16x16x32_bf16 v[40:43], v[36:39], v[84:87], v[40:43]
  s_nop 1
  v_mfma_f32_16x16x32_bf16 v[40:43], v[32:35], v[88:91], v[40:43]
  s_lshl_b32 s6, s2, 10
  s_lshl_b32 s7, s3, 9
  s_add_u32 s6, s6, s7
  s_add_u32 s6, s6, 0
  v_cmp_gt_u32 vcc, 32, v1
  s_nop 5
  v_bfi_b32 v40, v29, v7, v40
  v_bfi_b32 v41, v29, v7, v41
  v_bfi_b32 v42, v29, v7, v42
  v_bfi_b32 v43, v29, v7, v43
  s_and_saveexec_b64 s[84:85], vcc
  buffer_store_dwordx4 v[40:43], v30, s[80:83], s6 offen sc1
  s_mov_b64 exec, s[84:85]
  s_branch P1JOIN_6
W1_3:
  s_mov_b32 s52, s22
  s_and_b32 s53, s23, 0xffff
  s_mov_b32 s54, 4718592
  s_mov_b32 s55, 0x00020000
  v_lshlrev_b32 v4, 13, v2
  v_lshl_add_u32 v4, v3, 4, v4
  s_mul_i32 s6, s5, 294912
  s_lshl_b32 s7, s4, 1
  s_add_u32 s7, s7, s3
  s_lshl_b32 s7, s7, 8
  s_add_u32 s6, s6, s7
  buffer_load_dwordx4 v[56:59], v4, s[52:55], s6 offen nt
  s_add_u32 s6, s6, 32768
  buffer_load_dwordx4 v[60:63], v4, s[52:55], s6 offen nt
  s_add_u32 s6, s6, 32768
  buffer_load_dwordx4 v[64:67], v4, s[52:55], s6 offen nt
  s_add_u32 s6, s6, 32768
  buffer_load_dwordx4 v[68:71], v4, s[52:55], s6 offen nt
  s_add_u32 s6, s6, 32768
  buffer_load_dwordx4 v[72:75], v4, s[52:55], s6 offen nt
  s_add_u32 s6, s6, 32768
  buffer_load_dwordx4 v[76:79], v4, s[52:55], s6 offen nt
  s_add_u32 s6, s6, 32768
  buffer_load_dwordx4 v[80:83], v4, s[52:55], s6 offen nt
  s_add_u32 s6, s6, 32768
  buffer_load_dwordx4 v[84:87], v4, s[52:55], s6 offen nt
  s_add_u32 s6, s6, 32768
  buffer_load_dwordx4 v[88:91], v4, s[52:55], s6 offen nt
  s_mul_i32 s9, s5, 144
  v_mov_b32 v12, 45596
  v_mov_b32 v13, 1
  v_cmp_eq_u32 vcc, 0, v1
  s_and_saveexec_b64 s[84:85], vcc
  ds_add_u32 v12, v13
  s_mov_b64 exec, s[84:85]
  s_mov_b32 s40, s16
  s_and_b32 s41, s17, 0xffff
  s_mov_b32 s42, 1152
  s_mov_b32 s43, 0x00020000
  s_mov_b32 s56, s24
  s_and_b32 s57, s25, 0xffff
  s_mov_b32 s58, 4718592
  s_mov_b32 s59, 0x00020000
  s_mov_b32 s68, s32
  s_and_b32 s69, s33, 0xffff
  s_mov_b32 s70, 5308416
  s_mov_b32 s71, 0x00020000
  s_mov_b32 s72, s34
  s_and_b32 s73, s35, 0xffff
  s_mov_b32 s74, 1152
  s_mov_b32 s75, 0x00020000
  v_and_b32 v8, 7, v1
  v_and_b32 v9, 1, v1
  v_lshlrev_b32 v9, 4, v9
  v_mov_b32 v25, 0xffff
  v_lshlrev_b32 v9, v9, v25
  v_lshrrev_b32 v8, 1, v8
  v_cmp_eq_u32 vcc, 0, v8
  s_nop 1
  v_cndmask_b32 v25, 0, v9, vcc
  v_cmp_eq_u32 vcc, 1, v8
  s_nop 1
  v_cndmask_b32 v26, 0, v9, vcc
  v_cmp_eq_u32 vcc, 2, v8
  s_nop 1
  v_cndmask_b32 v27, 0, v9, vcc
  v_cmp_eq_u32 vcc, 3, v8
  s_nop 1
  v_cndmask_b32 v28, 0, v9, vcc
  v_mov_b32 v12, 45568
  s_mov_b32 s90, 0
LW_7:
  ds_read_b32 v13, v12
  s_waitcnt lgkmcnt(0)
  v_readfirstlane_b32 s93, v13
  s_nop 0
  s_cmp_ge_u32 s93, 1
  s_cbranch_scc1 LWD_8
  s_add_u32 s90, s90, 1
  s_cmp_lt_u32 s90, 2000000
  s_cbranch_scc1 LW_7
LWD_8:
  s_lshr_b32 s9, s9, 1
  v_lshl_add_u32 v10, v2, 1, s9
  ds_read_u16 v16, v10 offset:45632
  ds_read_u16 v17, v10 offset:45640
  ds_read_u16 v18, v10 offset:45648
  ds_read_u16 v19, v10 offset:45656
  ds_read_u16 v20, v10 offset:45664
  ds_read_u16 v21, v10 offset:45672
  ds_read_u16 v22, v10 offset:45680
  ds_read_u16 v23, v10 offset:45688
  ds_read_u16 v24, v10 offset:45696
  v_mov_b32 v12, 47680
  ds_read_b64 v[8:9], v12
  s_waitcnt lgkmcnt(0)
  s_add_u32 s97, s96, 1
  s_and_b32 s97, s97, 4095
  v_mov_b32 v29, 4095
  v_mov_b32 v7, s97
  v_lshlrev_b32 v16, 16, v16
  v_sub_f32 v16, v16, v8
  v_cvt_pk_bf16_f32 v16, v16, v16
  v_lshlrev_b32 v16, 16, v16
  v_mul_f32 v16, v16, v9
  v_cvt_pk_bf16_f32 v16, v16, v16
  v_lshlrev_b32 v17, 16, v17
  v_sub_f32 v17, v17, v8
  v_cvt_pk_bf16_f32 v17, v17, v17
  v_lshlrev_b32 v17, 16, v17
  v_mul_f32 v17, v17, v9
  v_cvt_pk_bf16_f32 v17, v17, v17
  v_lshlrev_b32 v18, 16, v18
  v_sub_f32 v18, v18, v8
  v_cvt_pk_bf16_f32 v18, v18, v18
  v_lshlrev_b32 v18, 16, v18
  v_mul_f32 v18, v18, v9
  v_cvt_pk_bf16_f32 v18, v18, v18
  v_lshlrev_b32 v19, 16, v19
  v_sub_f32 v19, v19, v8
  v_cvt_pk_bf16_f32 v19, v19, v19
  v_lshlrev_b32 v19, 16, v19
  v_mul_f32 v19, v19, v9
  v_cvt_pk_bf16_f32 v19, v19, v19
  v_lshlrev_b32 v20, 16, v20
  v_sub_f32 v20, v20, v8
  v_cvt_pk_bf16_f32 v20, v20, v20
  v_lshlrev_b32 v20, 16, v20
  v_mul_f32 v20, v20, v9
  v_cvt_pk_bf16_f32 v20, v20, v20
  v_lshlrev_b32 v21, 16, v21
  v_sub_f32 v21, v21, v8
  v_cvt_pk_bf16_f32 v21, v21, v21
  v_lshlrev_b32 v21, 16, v21
  v_mul_f32 v21, v21, v9
  v_cvt_pk_bf16_f32 v21, v21, v21
  v_lshlrev_b32 v22, 16, v22
  v_sub_f32 v22, v22, v8
  v_cvt_pk_bf16_f32 v22, v22, v22
  v_lshlrev_b32 v22, 16, v22
  v_mul_f32 v22, v22, v9
  v_cvt_pk_bf16_f32 v22, v22, v22
  v_lshlrev_b32 v23, 16, v23
  v_sub_f32 v23, v23, v8
  v_cvt_pk_bf16_f32 v23, v23, v23
  v_lshlrev_b32 v23, 16, v23
  v_mul_f32 v23, v23, v9
  v_cvt_pk_bf16_f32 v23, v23, v23
  v_lshlrev_b32 v24, 16, v24
  v_sub_f32 v24, v24, v8
  v_cvt_pk_bf16_f32 v24, v24, v24
  v_lshlrev_b32 v24, 16, v24
  v_mul_f32 v24, v24, v9
  v_cvt_pk_bf16_f32 v24, v24, v24
  s_waitcnt vmcnt(0)
  v_and_b32 v32, v16, v25
  v_and_b32 v33, v16, v26
  v_and_b32 v34, v16, v27
  v_and_b32 v35, v16, v28
  v_and_b32 v36, v17, v25
  v_and_b32 v37, v17, v26
  v_and_b32 v38, v17, v27
  v_and_b32 v39, v17, v28
  v_mfma_f32_16x16x32_bf16 v[40:43], v[32:35], v[56:59], 0
  v_and_b32 v32, v18, v25
  v_and_b32 v33, v18, v26
  v_and_b32 v34, v18, v27
  v_and_b32 v35, v18, v28
  v_mfma_f32_16x16x32_bf16 v[40:43], v[36:39], v[60:63], v[40:43]
  v_and_b32 v36, v19, v25
  v_and_b32 v37, v19, v26
  v_and_b32 v38, v19, v27
  v_and_b32 v39, v19, v28
  v_mfma_f32_16x16x32_bf16 v[40:43], v[32:35], v[64:67], v[40:43]
  v_and_b32 v32, v20, v25
  v_and_b32 v33, v20, v26
  v_and_b32 v34, v20, v27
  v_and_b32 v35, v20, v28
  v_mfma_f32_16x16x32_bf16 v[40:43], v[36:39], v[68:71], v[40:43]
  v_and_b32 v36, v21, v25
  v_and_b32 v37, v21, v26
  v_and_b32 v38, v21, v27
  v_and_b32 v39, v21, v28
  v_mfma_f32_16x16x32_bf16 v[40:43], v[32:35], v[72:75], v[40:43]
  v_and_b32 v32, v22, v25
  v_and_b32 v33, v22, v26
  v_and_b32 v34, v22, v27
  v_and_b32 v35, v22, v28
  v_mfma_f32_16x16x32_bf16 v[40:43], v[36:39], v[76:79], v[40:43]
  v_and_b32 v36, v23, v25
  v_and_b32 v37, v23, v26
  v_and_b32 v38, v23, v27
  v_and_b32 v39, v23, v28
  v_mfma_f32_16x16x32_bf16 v[40:43], v[32:35], v[80:83], v[40:43]
  v_and_b32 v32, v24, v25
  v_and_b32 v33, v24, v26
  v_and_b32 v34, v24, v27
  v_and_b32 v35, v24, v28
  v_mfma_f32_16x16x32_bf16 v[40:43], v[36:39], v[84:87], v[40:43]
  s_nop 1
  v_mfma_f32_16x16x32_bf16 v[40:43], v[32:35], v[88:91], v[40:43]
  s_lshl_b32 s6, s2, 10
  s_lshl_b32 s7, s3, 9
  s_add_u32 s6, s6, s7
  s_add_u32 s6, s6, 0
  v_cmp_gt_u32 vcc, 32, v1
  s_nop 5
  v_bfi_b32 v40, v29, v7, v40
  v_bfi_b32 v41, v29, v7, v41
  v_bfi_b32 v42, v29, v7, v42
  v_bfi_b32 v43, v29, v7, v43
  s_and_saveexec_b64 s[84:85], vcc
  buffer_store_dwordx4 v[40:43], v30, s[80:83], s6 offen sc1
  s_mov_b64 exec, s[84:85]
  s_branch P1JOIN_6
GU_4:
  s_mul_i32 s7, s7, 5
  s_add_u32 s6, s6, s7
  s_lshr_b32 s7, s2, 1
  s_and_b32 s7, s7, 3
  s_mul_i32 s7, s7, 9
  s_add_u32 s10, s6, s7
  s_mov_b32 s60, s28
  s_and_b32 s61, s29, 0xffff
  s_mov_b32 s62, 5308416
  s_mov_b32 s63, 0x00020000
  s_mov_b32 s64, s30
  s_and_b32 s65, s31, 0xffff
  s_mov_b32 s66, 5308416
  s_mov_b32 s67, 0x00020000
  s_movk_i32 s6, 9216
  v_mul_lo_u32 v5, v2, s6
  v_lshl_add_u32 v5, v3, 4, v5
  s_mul_i32 s6, s4, 331776
  s_lshl_b32 s7, s10, 8
  s_add_u32 s6, s6, s7
  s_bitcmp1_b32 s2, 3
  s_cbranch_scc1 UP_9
  buffer_load_dwordx4 v[56:59], v5, s[60:63], s6 offen nt
  s_add_u32 s6, s6, 36864
  buffer_load_dwordx4 v[60:63], v5, s[60:63], s6 offen nt
  s_add_u32 s6, s6, 36864
  buffer_load_dwordx4 v[64:67], v5, s[60:63], s6 offen nt
  s_add_u32 s6, s6, 36864
  buffer_load_dwordx4 v[68:71], v5, s[60:63], s6 offen nt
  s_add_u32 s6, s6, 36864
  buffer_load_dwordx4 v[72:75], v5, s[60:63], s6 offen nt
  s_add_u32 s6, s6, 36864
  buffer_load_dwordx4 v[76:79], v5, s[60:63], s6 offen nt
  s_add_u32 s6, s6, 36864
  buffer_load_dwordx4 v[80:83], v5, s[60:63], s6 offen nt
  s_add_u32 s6, s6, 36864
  buffer_load_dwordx4 v[84:87], v5, s[60:63], s6 offen nt
  s_add_u32 s6, s6, 36864
  buffer_load_dwordx4 v[88:91], v5, s[60:63], s6 offen nt
  s_branch GUJ_10
UP_9:
  buffer_load_dwordx4 v[56:59], v5, s[64:67], s6 offen nt
  s_add_u32 s6, s6, 36864
  buffer_load_dwordx4 v[60:63], v5, s[64:67], s6 offen nt
  s_add_u32 s6, s6, 36864
  buffer_load_dwordx4 v[64:67], v5, s[64:67], s6 offen nt
  s_add_u32 s6, s6, 36864
  buffer_load_dwordx4 v[68:71], v5, s[64:67], s6 offen nt
  s_add_u32 s6, s6, 36864
  buffer_load_dwordx4 v[72:75], v5, s[64:67], s6 offen nt
  s_add_u32 s6, s6, 36864
  buffer_load_dwordx4 v[76:79], v5, s[64:67], s6 offen nt
  s_add_u32 s6, s6, 36864
  buffer_load_dwordx4 v[80:83], v5, s[64:67], s6 offen nt
  s_add_u32 s6, s6, 36864
  buffer_load_dwordx4 v[84:87], v5, s[64:67], s6 offen nt
  s_add_u32 s6, s6, 36864
  buffer_load_dwordx4 v[88:91], v5, s[64:67], s6 offen nt
GUJ_10:
  s_mul_i32 s9, s4, 144
  v_mov_b32 v12, 45596
  v_mov_b32 v13, 1
  v_cmp_eq_u32 vcc, 0, v1
  s_and_saveexec_b64 s[84:85], vcc
  ds_add_u32 v12, v13
  s_mov_b64 exec, s[84:85]
  s_mov_b32 s40, s16
  s_and_b32 s41, s17, 0xffff
  s_mov_b32 s42, 1152
  s_mov_b32 s43, 0x00020000
  s_mov_b32 s56, s24
  s_and_b32 s57, s25, 0xffff
  s_mov_b32 s58, 4718592
  s_mov_b32 s59, 0x00020000
  s_mov_b32 s68, s32
  s_and_b32 s69, s33, 0xffff
  s_mov_b32 s70, 5308416
  s_mov_b32 s71, 0x00020000
  s_mov_b32 s72, s34
  s_and_b32 s73, s35, 0xffff
  s_mov_b32 s74, 1152
  s_mov_b32 s75, 0x00020000
  v_and_b32 v8, 7, v1
  v_and_b32 v9, 1, v1
  v_lshlrev_b32 v9, 4, v9
  v_mov_b32 v25, 0xffff
  v_lshlrev_b32 v9, v9, v25
  v_lshrrev_b32 v8, 1, v8
  v_cmp_eq_u32 vcc, 0, v8
  s_nop 1
  v_cndmask_b32 v25, 0, v9, vcc
  v_cmp_eq_u32 vcc, 1, v8
  s_nop 1
  v_cndmask_b32 v26, 0, v9, vcc
  v_cmp_eq_u32 vcc, 2, v8
  s_nop 1
  v_cndmask_b32 v27, 0, v9, vcc
  v_cmp_eq_u32 vcc, 3, v8
  s_nop 1
  v_cndmask_b32 v28, 0, v9, vcc
  v_mov_b32 v12, 45568
  s_mov_b32 s90, 0
LW_11:
  ds_read_b32 v13, v12
  s_waitcnt lgkmcnt(0)
  v_readfirstlane_b32 s93, v13
  s_nop 0
  s_cmp_ge_u32 s93, 1
  s_cbranch_scc1 LWD_12
  s_add_u32 s90, s90, 1
  s_cmp_lt_u32 s90, 2000000
  s_cbranch_scc1 LW_11
LWD_12:
  s_lshr_b32 s9, s9, 1
  v_lshl_add_u32 v10, v2, 1, s9
  ds_read_u16 v16, v10 offset:45632
  ds_read_u16 v17, v10 offset:45640
  ds_read_u16 v18, v10 offset:45648
  ds_read_u16 v19, v10 offset:45656
  ds_read_u16 v20, v10 offset:45664
  ds_read_u16 v21, v10 offset:45672
  ds_read_u16 v22, v10 offset:45680
  ds_read_u16 v23, v10 offset:45688
  ds_read_u16 v24, v10 offset:45696
  v_mov_b32 v12, 47680
  ds_read_b64 v[8:9], v12
  s_waitcnt lgkmcnt(0)
  s_add_u32 s97, s96, 1
  s_and_b32 s97, s97, 4095
  v_mov_b32 v29, 4095
  v_mov_b32 v7, s97
  v_lshlrev_b32 v16, 16, v16
  v_sub_f32 v16, v16, v8
  v_cvt_pk_bf16_f32 v16, v16, v16
  v_lshlrev_b32 v16, 16, v16
  v_mul_f32 v16, v16, v9
  v_cvt_pk_bf16_f32 v16, v16, v16
  v_lshlrev_b32 v17, 16, v17
  v_sub_f32 v17, v17, v8
  v_cvt_pk_bf16_f32 v17, v17, v17
  v_lshlrev_b32 v17, 16, v17
  v_mul_f32 v17, v17, v9
  v_cvt_pk_bf16_f32 v17, v17, v17
  v_lshlrev_b32 v18, 16, v18
  v_sub_f32 v18, v18, v8
  v_cvt_pk_bf16_f32 v18, v18, v18
  v_lshlrev_b32 v18, 16, v18
  v_mul_f32 v18, v18, v9
  v_cvt_pk_bf16_f32 v18, v18, v18
  v_lshlrev_b32 v19, 16, v19
  v_sub_f32 v19, v19, v8
  v_cvt_pk_bf16_f32 v19, v19, v19
  v_lshlrev_b32 v19, 16, v19
  v_mul_f32 v19, v19, v9
  v_cvt_pk_bf16_f32 v19, v19, v19
  v_lshlrev_b32 v20, 16, v20
  v_sub_f32 v20, v20, v8
  v_cvt_pk_bf16_f32 v20, v20, v20
  v_lshlrev_b32 v20, 16, v20
  v_mul_f32 v20, v20, v9
  v_cvt_pk_bf16_f32 v20, v20, v20
  v_lshlrev_b32 v21, 16, v21
  v_sub_f32 v21, v21, v8
  v_cvt_pk_bf16_f32 v21, v21, v21
  v_lshlrev_b32 v21, 16, v21
  v_mul_f32 v21, v21, v9
  v_cvt_pk_bf16_f32 v21, v21, v21
  v_lshlrev_b32 v22, 16, v22
  v_sub_f32 v22, v22, v8
  v_cvt_pk_bf16_f32 v22, v22, v22
  v_lshlrev_b32 v22, 16, v22
  v_mul_f32 v22, v22, v9
  v_cvt_pk_bf16_f32 v22, v22, v22
  v_lshlrev_b32 v23, 16, v23
  v_sub_f32 v23, v23, v8
  v_cvt_pk_bf16_f32 v23, v23, v23
  v_lshlrev_b32 v23, 16, v23
  v_mul_f32 v23, v23, v9
  v_cvt_pk_bf16_f32 v23, v23, v23
  v_lshlrev_b32 v24, 16, v24
  v_sub_f32 v24, v24, v8
  v_cvt_pk_bf16_f32 v24, v24, v24
  v_lshlrev_b32 v24, 16, v24
  v_mul_f32 v24, v24, v9
  v_cvt_pk_bf16_f32 v24, v24, v24
  s_waitcnt vmcnt(0)
  v_and_b32 v32, v16, v25
  v_and_b32 v33, v16, v26
  v_and_b32 v34, v16, v27
  v_and_b32 v35, v16, v28
  v_and_b32 v36, v17, v25
  v_and_b32 v37, v17, v26
  v_and_b32 v38, v17, v27
  v_and_b32 v39, v17, v28
  v_mfma_f32_16x16x32_bf16 v[40:43], v[32:35], v[56:59], 0
  v_and_b32 v32, v18, v25
  v_and_b32 v33, v18, v26
  v_and_b32 v34, v18, v27
  v_and_b32 v35, v18, v28
  v_mfma_f32_16x16x32_bf16 v[40:43], v[36:39], v[60:63], v[40:43]
  v_and_b32 v36, v19, v25
  v_and_b32 v37, v19, v26
  v_and_b32 v38, v19, v27
  v_and_b32 v39, v19, v28
  v_mfma_f32_16x16x32_bf16 v[40:43], v[32:35], v[64:67], v[40:43]
  v_and_b32 v32, v20, v25
  v_and_b32 v33, v20, v26
  v_and_b32 v34, v20, v27
  v_and_b32 v35, v20, v28
  v_mfma_f32_16x16x32_bf16 v[40:43], v[36:39], v[68:71], v[40:43]
  v_and_b32 v36, v21, v25
  v_and_b32 v37, v21, v26
  v_and_b32 v38, v21, v27
  v_and_b32 v39, v21, v28
  v_mfma_f32_16x16x32_bf16 v[40:43], v[32:35], v[72:75], v[40:43]
  v_and_b32 v32, v22, v25
  v_and_b32 v33, v22, v26
  v_and_b32 v34, v22, v27
  v_and_b32 v35, v22, v28
  v_mfma_f32_16x16x32_bf16 v[40:43], v[36:39], v[76:79], v[40:43]
  v_and_b32 v36, v23, v25
  v_and_b32 v37, v23, v26
  v_and_b32 v38, v23, v27
  v_and_b32 v39, v23, v28
  v_mfma_f32_16x16x32_bf16 v[40:43], v[32:35], v[80:83], v[40:43]
  v_and_b32 v32, v24, v25
  v_and_b32 v33, v24, v26
  v_and_b32 v34, v24, v27
  v_and_b32 v35, v24, v28
  v_mfma_f32_16x16x32_bf16 v[40:43], v[36:39], v[84:87], v[40:43]
  s_nop 1
  v_mfma_f32_16x16x32_bf16 v[40:43], v[32:35], v[88:91], v[40:43]
  s_lshr_b32 s6, s2, 3
  s_and_b32 s6, s6, 1
  s_lshl_b32 s6, s6, 4
  s_add_u32 s6, s6, s4
  s_mul_i32 s6, s6, 36
  s_add_u32 s6, s6, s10
  s_lshl_b32 s6, s6, 9
  s_add_u32 s6, s6, 262144
  v_cmp_gt_u32 vcc, 32, v1
  s_nop 5
  v_bfi_b32 v40, v29, v7, v40
  v_bfi_b32 v41, v29, v7, v41
  v_bfi_b32 v42, v29, v7, v42
  v_bfi_b32 v43, v29, v7, v43
  s_and_saveexec_b64 s[84:85], vcc
  buffer_store_dwordx4 v[40:43], v30, s[80:83], s6 offen sc1
  s_mov_b64 exec, s[84:85]
  s_branch P1JOIN_6
NONE_5:
  v_mov_b32 v12, 45596
  v_mov_b32 v13, 1
  v_cmp_eq_u32 vcc, 0, v1
  s_and_saveexec_b64 s[84:85], vcc
  ds_add_u32 v12, v13
  s_mov_b64 exec, s[84:85]
  s_mov_b32 s40, s16
  s_and_b32 s41, s17, 0xffff
  s_mov_b32 s42, 1152
  s_mov_b32 s43, 0x00020000
  s_mov_b32 s56, s24
  s_and_b32 s57, s25, 0xffff
  s_mov_b32 s58, 4718592
  s_mov_b32 s59, 0x00020000
  s_mov_b32 s68, s32
  s_and_b32 s69, s33, 0xffff
  s_mov_b32 s70, 5308416
  s_mov_b32 s71, 0x00020000
  s_mov_b32 s72, s34
  s_and_b32 s73, s35, 0xffff
  s_mov_b32 s74, 1152
  s_mov_b32 s75, 0x00020000
  s_waitcnt lgkmcnt(0)
  s_add_u32 s97, s96, 1
  s_and_b32 s97, s97, 4095
  v_mov_b32 v29, 4095
  v_mov_b32 v7, s97
P1JOIN_6:
  s_cmp_lt_u32 s3, 2
  s_cbranch_scc1 QG_14
  s_cmp_lt_u32 s3, 6
  s_cbranch_scc1 NOQ_13
QG_14:
  s_cmp_lg_u32 s3, 7
  s_cbranch_scc1 NOIND_15
  v_bfe_u32 v12, v1, 1, 4
  v_and_b32 v13, 1, v1
  v_lshlrev_b32 v15, 10, v12
  v_lshl_add_u32 v15, v13, 9, v15
  s_lshl_b32 s6, s4, 14
  s_add_u32 s6, s6, 496
  s_mov_b64 s[84:85], exec
  s_mov_b32 s90, 0
POLL_16:
  buffer_load_dwordx4 v[48:51], v15, s[80:83], s6 offen offset:0 sc1
  s_waitcnt vmcnt(0)
  v_xor_b32 v13, v48, v7
  v_xor_b32 v14, v49, v7
  v_or_b32 v13, v13, v14
  v_xor_b32 v14, v50, v7
  v_or_b32 v13, v13, v14
  v_xor_b32 v14, v51, v7
  v_or_b32 v13, v13, v14
  v_and_b32 v13, 4095, v13
  v_cmp_ne_u32 vcc, 0, v13
  s_nop 1
  s_and_b64 vcc, vcc, exec
  s_cmp_eq_u64 vcc, 0
  s_cbranch_scc1 PDONE_17
  s_add_u32 s90, s90, 1
  s_cmp_gt_u32 s90, 20000
  s_cbranch_scc1 PDONE_17
  s_mov_b64 exec, vcc
  s_branch POLL_16
PDONE_17:
  s_mov_b64 exec, s[84:85]
  s_nop 0
  v_mov_b32 v12, 45600
  v_mov_b32 v13, 1
  v_cmp_eq_u32 vcc, 0, v1
  s_and_saveexec_b64 s[84:85], vcc
  ds_add_u32 v12, v13
  s_mov_b64 exec, s[84:85]
NOIND_15:
  v_mov_b32 v12, 45600
  s_mov_b32 s90, 0
LW_18:
  ds_read_b32 v13, v12
  s_waitcnt lgkmcnt(0)
  v_readfirstlane_b32 s93, v13
  s_nop 0
  s_cmp_ge_u32 s93, 1
  s_cbranch_scc1 LWD_19
  s_add_u32 s90, s90, 1
  s_cmp_lt_u32 s90, 2000000
  s_cbranch_scc1 LW_18
LWD_19:
  s_sub_u32 s8, s3, 4
  s_cmp_lt_u32 s3, 2
  s_cselect_b32 s8, s3, s8
  v_lshlrev_b32 v12, 10, v2
  v_lshl_add_u32 v15, v3, 4, v12
  s_lshl_b32 s6, s4, 14
  s_lshl_b32 s7, s8, 8
  s_add_u32 s6, s6, s7
  s_add_u32 s6, s6, 0
  s_add_u32 s7, s6, 4096
  s_add_u32 s9, s6, 8192
  s_add_u32 s10, s6, 12288
  s_mov_b64 s[84:85], exec
  s_mov_b32 s90, 0
POLL_20:
  buffer_load_dwordx4 v[48:51], v15, s[80:83], s6 offen offset:0 sc1
  buffer_load_dwordx4 v[52:55], v15, s[80:83], s7 offen offset:0 sc1
  buffer_load_dwordx4 v[56:59], v15, s[80:83], s9 offen offset:0 sc1
  buffer_load_dwordx4 v[60:63], v15, s[80:83], s10 offen offset:0 sc1
  s_waitcnt vmcnt(0)
  v_xor_b32 v13, v48, v7
  v_xor_b32 v14, v49, v7
  v_or_b32 v13, v13, v14
  v_xor_b32 v14, v50, v7
  v_or_b32 v13, v13, v14
  v_xor_b32 v14, v51, v7
  v_or_b32 v13, v13, v14
  v_xor_b32 v14, v52, v7
  v_or_b32 v13, v13, v14
  v_xor_b32 v14, v53, v7
  v_or_b32 v13, v13, v14
  v_xor_b32 v14, v54, v7
  v_or_b32 v13, v13, v14
  v_xor_b32 v14, v55, v7
  v_or_b32 v13, v13, v14
  v_xor_b32 v14, v56, v7
  v_or_b32 v13, v13, v14
  v_xor_b32 v14, v57, v7
  v_or_b32 v13, v13, v14
  v_xor_b32 v14, v58, v7
  v_or_b32 v13, v13, v14
  v_xor_b32 v14, v59, v7
  v_or_b32 v13, v13, v14
  v_xor_b32 v14, v60, v7
  v_or_b32 v13, v13, v14
  v_xor_b32 v14, v61, v7
  v_or_b32 v13, v13, v14
  v_xor_b32 v14, v62, v7
  v_or_b32 v13, v13, v14
  v_xor_b32 v14, v63, v7
  v_or_b32 v13, v13, v14
  v_and_b32 v13, 4095, v13
  v_cmp_ne_u32 vcc, 0, v13
  s_nop 1
  s_and_b64 vcc, vcc, exec
  s_cmp_eq_u64 vcc, 0
  s_cbranch_scc1 PDONE_21
  s_add_u32 s90, s90, 1
  s_cmp_gt_u32 s90, 20000
  s_cbranch_scc1 PDONE_21
  s_mov_b64 exec, vcc
  s_branch POLL_20
PDONE_21:
  s_mov_b64 exec, s[84:85]
  s_nop 0
  v_and_b32 v48, 0xfffff000, v48
  v_and_b32 v49, 0xfffff000, v49
  v_and_b32 v50, 0xfffff000, v50
  v_and_b32 v51, 0xfffff000, v51
  v_and_b32 v52, 0xfffff000, v52
  v_and_b32 v53, 0xfffff000, v53
  v_and_b32 v54, 0xfffff000, v54
  v_and_b32 v55, 0xfffff000, v55
  v_and_b32 v56, 0xfffff000, v56
  v_and_b32 v57, 0xfffff000, v57
  v_and_b32 v58, 0xfffff000, v58
  v_and_b32 v59, 0xfffff000, v59
  v_and_b32 v60, 0xfffff000, v60
  v_and_b32 v61, 0xfffff000, v61
  v_and_b32 v62, 0xfffff000, v62
  v_and_b32 v63, 0xfffff000, v63
  v_add_f32 v48, v48, v52
  v_add_f32 v56, v56, v60
  v_add_f32 v49, v49, v53
  v_add_f32 v57, v57, v61
  v_add_f32 v50, v50, v54
  v_add_f32 v58, v58, v62
  v_add_f32 v51, v51, v55
  v_add_f32 v59, v59, v63
  v_add_f32 v48, v48, v56
  v_add_f32 v49, v49, v57
  v_add_f32 v50, v50, v58
  v_add_f32 v51, v51, v59
  v_mov_b32 v12, v48
  s_nop 1
  v_permlane16_swap_b32 v48, v12
  s_nop 0
  v_add_f32 v48, v48, v12
  v_mov_b32 v12, v48
  s_nop 1
  v_permlane32_swap_b32 v48, v12
  s_nop 0
  v_add_f32 v48, v48, v12
  v_mov_b32 v12, v49
  s_nop 1
  v_permlane16_swap_b32 v49, v12
  s_nop 0
  v_add_f32 v49, v49, v12
  v_mov_b32 v12, v49
  s_nop 1
  v_permlane32_swap_b32 v49, v12
  s_nop 0
  v_add_f32 v49, v49, v12
  v_mov_b32 v12, v50
  s_nop 1
  v_permlane16_swap_b32 v50, v12
  s_nop 0
  v_add_f32 v50, v50, v12
  v_mov_b32 v12, v50
  s_nop 1
  v_permlane32_swap_b32 v50, v12
  s_nop 0
  v_add_f32 v50, v50, v12
  v_mov_b32 v12, v51
  s_nop 1
  v_permlane16_swap_b32 v51, v12
  s_nop 0
  v_add_f32 v51, v51, v12
  v_mov_b32 v12, v51
  s_nop 1
  v_permlane32_swap_b32 v51, v12
  s_nop 0
  v_add_f32 v51, v51, v12
  v_cvt_pk_bf16_f32 v48, v48, v49
  v_cvt_pk_bf16_f32 v49, v50, v51
  s_lshl_b32 s6, s8, 7
  v_lshl_add_u32 v12, v3, 3, s6
  ds_write_b64 v12, v[48:49] offset:8192
  v_mov_b32 v12, 45576
  v_mov_b32 v13, 1
  v_cmp_eq_u32 vcc, 0, v1
  s_and_saveexec_b64 s[84:85], vcc
  ds_add_u32 v12, v13
  s_mov_b64 exec, s[84:85]
NOQ_13:
  v_lshrrev_b32 v6, 3, v3
  v_lshl_add_u32 v6, v2, 1, v6
  s_movk_i32 s6, 1152
  v_mul_lo_u32 v6, v6, s6
  v_and_b32 v12, 7, v3
  v_lshl_add_u32 v6, v12, 4, v6
  s_cmp_ge_u32 s3, 5
  s_cbranch_scc1 P2RED_24
  s_cmp_ge_u32 s3, 2
  s_cbranch_scc1 P2DOWN_22
  s_lshl_b32 s6, s2, 4
  s_lshl_b32 s7, s3, 3
  s_add_u32 s6, s6, s7
  s_mul_i32 s6, s6, 1152
  v_mov_b32 v12, 45572
  s_mov_b32 s90, 0
LW_25:
  ds_read_b32 v13, v12
  s_waitcnt lgkmcnt(0)
  v_readfirstlane_b32 s93, v13
  s_nop 0
  s_cmp_ge_u32 s93, 8
  s_cbranch_scc1 LWD_26
  s_add_u32 s90, s90, 1
  s_cmp_lt_u32 s90, 2000000
  s_cbranch_scc1 LW_25
LWD_26:
  buffer_load_dwordx4 v[92:95], v6, s[56:59], s6 offen offset:0 nt
  buffer_load_dwordx4 v[96:99], v6, s[56:59], s6 offen offset:128 nt
  buffer_load_dwordx4 v[100:103], v6, s[56:59], s6 offen offset:256 nt
  buffer_load_dwordx4 v[104:107], v6, s[56:59], s6 offen offset:384 nt
  buffer_load_dwordx4 v[108:111], v6, s[56:59], s6 offen offset:512 nt
  buffer_load_dwordx4 v[112:115], v6, s[56:59], s6 offen offset:640 nt
  buffer_load_dwordx4 v[116:119], v6, s[56:59], s6 offen offset:768 nt
  buffer_load_dwordx4 v[120:123], v6, s[56:59], s6 offen offset:896 nt
  buffer_load_dwordx4 v[124:127], v6, s[56:59], s6 offen offset:1024 nt
  v_bfe_u32 v12, v1, 1, 4
  v_and_b32 v13, 1, v1
  v_lshlrev_b32 v14, 10, v12
  v_lshl_add_u32 v14, v13, 4, v14
  v_lshlrev_b32 v15, 5, v12
  s_lshl_b32 s6, s4, 14
  s_lshr_b32 s7, s5, 3
  s_lshl_b32 s9, s7, 9
  s_add_u32 s6, s6, s9
  s_and_b32 s9, s5, 7
  s_lshl_b32 s9, s9, 6
  s_add_u32 s6, s6, s9
  s_mov_b32 s8, s3
  s_lshl_b32 s9, s8, 5
  s_add_u32 s6, s6, s9
  s_add_u32 s6, s6, 851968
  s_lshl_b32 s9, s4, 9
  s_lshl_b32 s7, s7, 4
  s_add_u32 s9, s9, s7
  s_add_u32 s9, s9, 1114112
  s_mov_b64 s[84:85], exec
  s_mov_b32 s90, 0
POLL_27:
  buffer_load_dwordx4 v[8:11], v14, s[80:83], s6 offen offset:0 sc1
  buffer_load_dwordx4 v[48:51], v15, s[80:83], s9 offen offset:0 sc1
  s_waitcnt vmcnt(0)
  v_xor_b32 v12, v8, v7
  v_xor_b32 v13, v9, v7
  v_or_b32 v12, v12, v13
  v_xor_b32 v13, v10, v7
  v_or_b32 v12, v12, v13
  v_xor_b32 v13, v11, v7
  v_or_b32 v12, v12, v13
  v_xor_b32 v13, v48, v7
  v_or_b32 v12, v12, v13
  v_xor_b32 v13, v49, v7
  v_or_b32 v12, v12, v13
  v_xor_b32 v13, v50, v7
  v_or_b32 v12, v12, v13
  v_xor_b32 v13, v51, v7
  v_or_b32 v12, v12, v13
  v_and_b32 v12, 4095, v12
  v_cmp_ne_u32 vcc, 0, v12
  s_nop 1
  s_and_b64 vcc, vcc, exec
  s_cmp_eq_u64 vcc, 0
  s_cbranch_scc1 PDONE_28
  s_add_u32 s90, s90, 1
  s_cmp_gt_u32 s90, 20000
  s_cbranch_scc1 PDONE_28
  s_mov_b64 exec, vcc
  s_branch POLL_27
PDONE_28:
  s_mov_b64 exec, s[84:85]
  s_nop 0
  v_and_b32 v8, 0xfffff000, v8
  v_and_b32 v9, 0xfffff000, v9
  v_and_b32 v10, 0xfffff000, v10
  v_and_b32 v11, 0xfffff000, v11
  v_and_b32 v48, 0xfffff000, v48
  v_and_b32 v49, 0xfffff000, v49
  v_and_b32 v50, 0xfffff000, v50
  v_and_b32 v51, 0xfffff000, v51
  v_mov_b32 v50, v48
  s_nop 1
  v_max_f32_dpp v50, v50, v50 row_ror:2 row_mask:0xf bank_mask:0xf
  s_nop 1
  v_max_f32_dpp v50, v50, v50 row_ror:4 row_mask:0xf bank_mask:0xf
  s_nop 1
  v_max_f32_dpp v50, v50, v50 row_ror:8 row_mask:0xf bank_mask:0xf
  v_mov_b32 v12, v50
  s_nop 1
  v_permlane16_swap_b32 v50, v12
  s_nop 0
  v_max_f32 v50, v50, v12
  v_sub_f32 v48, v48, v50
  v_mul_f32 v48, s92, v48
  v_exp_f32 v48, v48
  s_nop 0
  v_mul_f32 v49, v49, v48
  s_nop 1
  v_add_f32_dpp v49, v49, v49 row_ror:2 row_mask:0xf bank_mask:0xf
  s_nop 1
  v_add_f32_dpp v49, v49, v49 row_ror:4 row_mask:0xf bank_mask:0xf
  s_nop 1
  v_add_f32_dpp v49, v49, v49 row_ror:8 row_mask:0xf bank_mask:0xf
  v_mov_b32 v12, v49
  s_nop 1
  v_permlane16_swap_b32 v49, v12
  s_nop 0
  v_add_f32 v49, v49, v12
  v_mul_f32 v8, v8, v48
  s_nop 1
  v_add_f32_dpp v8, v8, v8 row_ror:2 row_mask:0xf bank_mask:0xf
  s_nop 1
  v_add_f32_dpp v8, v8, v8 row_ror:4 row_mask:0xf bank_mask:0xf
  s_nop 1
  v_add_f32_dpp v8, v8, v8 row_ror:8 row_mask:0xf bank_mask:0xf
  v_mov_b32 v12, v8
  s_nop 1
  v_permlane16_swap_b32 v8, v12
  s_nop 0
  v_add_f32 v8, v8, v12
  v_mul_f32 v9, v9, v48
  s_nop 1
  v_add_f32_dpp v9, v9, v9 row_ror:2 row_mask:0xf bank_mask:0xf
  s_nop 1
  v_add_f32_dpp v9, v9, v9 row_ror:4 row_mask:0xf bank_mask:0xf
  s_nop 1
  v_add_f32_dpp v9, v9, v9 row_ror:8 row_mask:0xf bank_mask:0xf
  v_mov_b32 v12, v9
  s_nop 1
  v_permlane16_swap_b32 v9, v12
  s_nop 0
  v_add_f32 v9, v9, v12
  v_mul_f32 v10, v10, v48
  s_nop 1
  v_add_f32_dpp v10, v10, v10 row_ror:2 row_mask:0xf bank_mask:0xf
  s_nop 1
  v_add_f32_dpp v10, v10, v10 row_ror:4 row_mask:0xf bank_mask:0xf
  s_nop 1
  v_add_f32_dpp v10, v10, v10 row_ror:8 row_mask:0xf bank_mask:0xf
  v_mov_b32 v12, v10
  s_nop 1
  v_permlane16_swap_b32 v10, v12
  s_nop 0
  v_add_f32 v10, v10, v12
  v_mul_f32 v11, v11, v48
  s_nop 1
  v_add_f32_dpp v11, v11, v11 row_ror:2 row_mask:0xf bank_mask:0xf
  s_nop 1
  v_add_f32_dpp v11, v11, v11 row_ror:4 row_mask:0xf bank_mask:0xf
  s_nop 1
  v_add_f32_dpp v11, v11, v11 row_ror:8 row_mask:0xf bank_mask:0xf
  v_mov_b32 v12, v11
  s_nop 1
  v_permlane16_swap_b32 v11, v12
  s_nop 0
  v_add_f32 v11, v11, v12
  v_rcp_f32 v49, v49
  s_nop 0
  v_mul_f32 v8, v8, v49
  v_cvt_pk_bf16_f32 v12, v8, v8
  v_lshlrev_b32 v8, 16, v12
  v_mul_f32 v9, v9, v49
  v_cvt_pk_bf16_f32 v12, v9, v9
  v_lshlrev_b32 v9, 16, v12
  v_mul_f32 v10, v10, v49
  v_cvt_pk_bf16_f32 v12, v10, v10
  v_lshlrev_b32 v10, 16, v12
  v_mul_f32 v11, v11, v49
  v_cvt_pk_bf16_f32 v12, v11, v11
  v_lshlrev_b32 v11, 16, v12
  s_lshl_b32 s6, s3, 5
  s_add_u32 s6, s6, 8704
  v_and_b32 v12, 1, v1
  v_lshl_add_u32 v12, v12, 4, s6
  v_cmp_gt_u32 vcc, 2, v1
  s_nop 1
  s_and_saveexec_b64 s[84:85], vcc
  ds_write_b128 v12, v[8:11]
  s_mov_b64 exec, s[84:85]
  v_lshrrev_b32 v12, 3, v3
  v_lshl_add_u32 v12, v2, 1, v12
  v_lshl_add_u32 v12, v12, 2, s6
  ds_read_b32 v16, v12
  s_waitcnt lgkmcnt(0)
  v_cvt_pk_bf16_f32 v16, v16, v16
  v_and_b32 v12, 7, v1
  v_and_b32 v13, 1, v1
  v_lshlrev_b32 v13, 4, v13
  v_mov_b32 v25, 0xffff
  v_lshlrev_b32 v13, v13, v25
  v_lshrrev_b32 v12, 1, v12
  v_cmp_eq_u32 vcc, 0, v12
  s_nop 1
  v_cndmask_b32 v25, 0, v13, vcc
  v_cmp_eq_u32 vcc, 1, v12
  s_nop 1
  v_cndmask_b32 v26, 0, v13, vcc
  v_cmp_eq_u32 vcc, 2, v12
  s_nop 1
  v_cndmask_b32 v27, 0, v13, vcc
  v_cmp_eq_u32 vcc, 3, v12
  s_nop 1
  v_cndmask_b32 v28, 0, v13, vcc
  v_and_b32 v32, v16, v25
  v_and_b32 v33, v16, v26
  v_and_b32 v34, v16, v27
  v_and_b32 v35, v16, v28
  s_waitcnt vmcnt(0)
  s_nop 1
  v_mfma_f32_16x16x32_bf16 v[56:59], v[32:35], v[92:95], 0
  v_mfma_f32_16x16x32_bf16 v[60:63], v[32:35], v[96:99], 0
  v_mfma_f32_16x16x32_bf16 v[64:67], v[32:35], v[100:103], 0
  v_mfma_f32_16x16x32_bf16 v[68:71], v[32:35], v[104:107], 0
  v_mfma_f32_16x16x32_bf16 v[72:75], v[32:35], v[108:111], 0
  v_mfma_f32_16x16x32_bf16 v[76:79], v[32:35], v[112:115], 0
  v_mfma_f32_16x16x32_bf16 v[80:83], v[32:35], v[116:119], 0
  v_mfma_f32_16x16x32_bf16 v[84:87], v[32:35], v[120:123], 0
  v_mfma_f32_16x16x32_bf16 v[88:91], v[32:35], v[124:127], 0
  v_lshrrev_b32 v12, 3, v3
  s_movk_i32 s7, 2304
  v_mul_lo_u32 v13, v12, s7
  v_and_b32 v14, 7, v3
  v_lshl_add_u32 v13, v14, 5, v13
  v_and_b32 v14, 1, v2
  v_lshl_add_u32 v13, v14, 4, v13
  s_mul_i32 s7, s8, 4608
  s_add_u32 s7, s7, 35840
  v_add_u32 v13, s7, v13
  v_lshrrev_b32 v14, 1, v2
  v_cmp_eq_u32 vcc, v12, v14
  s_nop 1
  s_and_saveexec_b64 s[84:85], vcc
  ds_write_b128 v13, v[56:59] offset:0
  ds_write_b128 v13, v[60:63] offset:256
  ds_write_b128 v13, v[64:67] offset:512
  ds_write_b128 v13, v[68:71] offset:768
  ds_write_b128 v13, v[72:75] offset:1024
  ds_write_b128 v13, v[76:79] offset:1280
  ds_write_b128 v13, v[80:83] offset:1536
  ds_write_b128 v13, v[84:87] offset:1792
  ds_write_b128 v13, v[88:91] offset:2048
  s_mov_b64 exec, s[84:85]
  v_mov_b32 v12, 45588
  v_mov_b32 v13, 1
  v_cmp_eq_u32 vcc, 0, v1
  s_and_saveexec_b64 s[84:85], vcc
  ds_add_u32 v12, v13
  s_mov_b64 exec, s[84:85]
  s_branch P2JOIN_23
P2DOWN_22:
  s_and_b32 s9, s2, 3
  s_lshl_b32 s10, s9, 1
  s_add_u32 s10, s10, 1
  s_cmp_eq_u32 s9, 0
  s_cselect_b32 s10, 0, s10
  s_cselect_b32 s11, 3, 2
  s_sub_u32 s8, s3, 2
  s_cmp_ge_u32 s8, s11
  s_cbranch_scc1 P2JOIN_23
  s_lshr_b32 s9, s2, 2
  s_mul_i32 s9, s9, 9
  s_add_u32 s9, s9, s10
  s_add_u32 s9, s9, s8
  v_lshrrev_b32 v8, 5, v1
  v_lshlrev_b32 v8, 4, v8
  v_bfe_u32 v9, v1, 1, 4
  v_add_u32 v8, v8, v9
  s_movk_i32 s10, 18432
  v_mul_lo_u32 v8, v8, s10
  v_and_b32 v9, 1, v1
  v_lshl_add_u32 v15, v9, 4, v8
  s_lshl_b32 s10, s9, 5
  s_add_u32 s10, s10, 262144
  s_mov_b64 s[84:85], exec
  s_mov_b32 s90, 0
POLL_29:
  buffer_load_dwordx4 v[8:11], v15, s[80:83], s10 offen offset:0 sc1
  s_waitcnt vmcnt(0)
  v_xor_b32 v13, v8, v7
  v_xor_b32 v14, v9, v7
  v_or_b32 v13, v13, v14
  v_xor_b32 v14, v10, v7
  v_or_b32 v13, v13, v14
  v_xor_b32 v14, v11, v7
  v_or_b32 v13, v13, v14
  v_and_b32 v13, 4095, v13
  v_cmp_ne_u32 vcc, 0, v13
  s_nop 1
  s_and_b64 vcc, vcc, exec
  s_cmp_eq_u64 vcc, 0
  s_cbranch_scc1 PDONE_30
  s_add_u32 s90, s90, 1
  s_cmp_gt_u32 s90, 20000
  s_cbranch_scc1 PDONE_30
  s_mov_b64 exec, vcc
  s_branch POLL_29
PDONE_30:
  s_mov_b64 exec, s[84:85]
  s_nop 0
  v_and_b32 v8, 0xfffff000, v8
  v_and_b32 v9, 0xfffff000, v9
  v_and_b32 v10, 0xfffff000, v10
  v_and_b32 v11, 0xfffff000, v11
  s_mul_i32 s6, s9, 9216
  v_mov_b32 v12, 45572
  s_mov_b32 s90, 0
LW_31:
  ds_read_b32 v13, v12
  s_waitcnt lgkmcnt(0)
  v_readfirstlane_b32 s93, v13
  s_nop 0
  s_cmp_ge_u32 s93, 8
  s_cbranch_scc1 LWD_32
  s_add_u32 s90, s90, 1
  s_cmp_lt_u32 s90, 2000000
  s_cbranch_scc1 LW_31
LWD_32:
  buffer_load_dwordx4 v[92:95], v6, s[68:71], s6 offen offset:0 nt
  buffer_load_dwordx4 v[96:99], v6, s[68:71], s6 offen offset:128 nt
  buffer_load_dwordx4 v[100:103], v6, s[68:71], s6 offen offset:256 nt
  buffer_load_dwordx4 v[104:107], v6, s[68:71], s6 offen offset:384 nt
  buffer_load_dwordx4 v[108:111], v6, s[68:71], s6 offen offset:512 nt
  buffer_load_dwordx4 v[112:115], v6, s[68:71], s6 offen offset:640 nt
  buffer_load_dwordx4 v[116:119], v6, s[68:71], s6 offen offset:768 nt
  buffer_load_dwordx4 v[120:123], v6, s[68:71], s6 offen offset:896 nt
  buffer_load_dwordx4 v[124:127], v6, s[68:71], s6 offen offset:1024 nt
  s_nop 1
  v_add_f32_dpp v8, v8, v8 row_ror:2 row_mask:0xf bank_mask:0xf
  s_nop 1
  v_add_f32_dpp v8, v8, v8 row_ror:4 row_mask:0xf bank_mask:0xf
  s_nop 1
  v_add_f32_dpp v8, v8, v8 row_ror:8 row_mask:0xf bank_mask:0xf
  v_mov_b32 v12, v8
  s_nop 1
  v_permlane16_swap_b32 v8, v12
  s_nop 0
  v_add_f32 v8, v8, v12
  s_nop 1
  v_add_f32_dpp v9, v9, v9 row_ror:2 row_mask:0xf bank_mask:0xf
  s_nop 1
  v_add_f32_dpp v9, v9, v9 row_ror:4 row_mask:0xf bank_mask:0xf
  s_nop 1
  v_add_f32_dpp v9, v9, v9 row_ror:8 row_mask:0xf bank_mask:0xf
  v_mov_b32 v12, v9
  s_nop 1
  v_permlane16_swap_b32 v9, v12
  s_nop 0
  v_add_f32 v9, v9, v12
  s_nop 1
  v_add_f32_dpp v10, v10, v10 row_ror:2 row_mask:0xf bank_mask:0xf
  s_nop 1
  v_add_f32_dpp v10, v10, v10 row_ror:4 row_mask:0xf bank_mask:0xf
  s_nop 1
  v_add_f32_dpp v10, v10, v10 row_ror:8 row_mask:0xf bank_mask:0xf
  v_mov_b32 v12, v10
  s_nop 1
  v_permlane16_swap_b32 v10, v12
  s_nop 0
  v_add_f32 v10, v10, v12
  s_nop 1
  v_add_f32_dpp v11, v11, v11 row_ror:2 row_mask:0xf bank_mask:0xf
  s_nop 1
  v_add_f32_dpp v11, v11, v11 row_ror:4 row_mask:0xf bank_mask:0xf
  s_nop 1
  v_add_f32_dpp v11, v11, v11 row_ror:8 row_mask:0xf bank_mask:0xf
  v_mov_b32 v12, v11
  s_nop 1
  v_permlane16_swap_b32 v11, v12
  s_nop 0
  v_add_f32 v11, v11, v12
  v_cvt_pk_bf16_f32 v12, v8, v8
  v_lshlrev_b32 v8, 16, v12
  v_cvt_pk_bf16_f32 v12, v9, v9
  v_lshlrev_b32 v9, 16, v12
  v_cvt_pk_bf16_f32 v12, v10, v10
  v_lshlrev_b32 v10, 16, v12
  v_cvt_pk_bf16_f32 v12, v11, v11
  v_lshlrev_b32 v11, 16, v12
  v_mov_b32 v48, v8
  v_mov_b32 v49, v9
  v_mov_b32 v50, v10
  v_mov_b32 v51, v11
  s_nop 1
  v_permlane32_swap_b32 v8, v48
  v_permlane32_swap_b32 v9, v49
  v_permlane32_swap_b32 v10, v50
  v_permlane32_swap_b32 v11, v51
  s_nop 0
  v_mul_f32 v12, 0xbfb8aa3b, v8
  v_exp_f32 v12, v12
  s_nop 0
  v_add_f32 v12, 1.0, v12
  v_rcp_f32 v12, v12
  s_nop 0
  v_mul_f32 v8, v8, v12
  v_cvt_pk_bf16_f32 v12, v8, v8
  v_lshlrev_b32 v8, 16, v12
  v_mul_f32 v8, v8, v48
  v_cvt_pk_bf16_f32 v12, v8, v8
  v_lshlrev_b32 v8, 16, v12
  v_mul_f32 v12, 0xbfb8aa3b, v9
  v_exp_f32 v12, v12
  s_nop 0
  v_add_f32 v12, 1.0, v12
  v_rcp_f32 v12, v12
  s_nop 0
  v_mul_f32 v9, v9, v12
  v_cvt_pk_bf16_f32 v12, v9, v9
  v_lshlrev_b32 v9, 16, v12
  v_mul_f32 v9, v9, v49
  v_cvt_pk_bf16_f32 v12, v9, v9
  v_lshlrev_b32 v9, 16, v12
  v_mul_f32 v12, 0xbfb8aa3b, v10
  v_exp_f32 v12, v12
  s_nop 0
  v_add_f32 v12, 1.0, v12
  v_rcp_f32 v12, v12
  s_nop 0
  v_mul_f32 v10, v10, v12
  v_cvt_pk_bf16_f32 v12, v10, v10
  v_lshlrev_b32 v10, 16, v12
  v_mul_f32 v10, v10, v50
  v_cvt_pk_bf16_f32 v12, v10, v10
  v_lshlrev_b32 v10, 16, v12
  v_mul_f32 v12, 0xbfb8aa3b, v11
  v_exp_f32 v12, v12
  s_nop 0
  v_add_f32 v12, 1.0, v12
  v_rcp_f32 v12, v12
  s_nop 0
  v_mul_f32 v11, v11, v12
  v_cvt_pk_bf16_f32 v12, v11, v11
  v_lshlrev_b32 v11, 16, v12
  v_mul_f32 v11, v11, v51
  v_cvt_pk_bf16_f32 v12, v11, v11
  v_lshlrev_b32 v11, 16, v12
  s_lshl_b32 s6, s3, 5
  s_add_u32 s6, s6, 8704
  v_and_b32 v12, 1, v1
  v_lshl_add_u32 v12, v12, 4, s6
  v_cmp_gt_u32 vcc, 2, v1
  s_nop 1
  s_and_saveexec_b64 s[84:85], vcc
  ds_write_b128 v12, v[8:11]
  s_mov_b64 exec, s[84:85]
  v_lshrrev_b32 v12, 3, v3
  v_lshl_add_u32 v12, v2, 1, v12
  v_lshl_add_u32 v12, v12, 2, s6
  ds_read_b32 v16, v12
  s_waitcnt lgkmcnt(0)
  v_cvt_pk_bf16_f32 v16, v16, v16
  v_and_b32 v12, 7, v1
  v_and_b32 v13, 1, v1
  v_lshlrev_b32 v13, 4, v13
  v_mov_b32 v25, 0xffff
  v_lshlrev_b32 v13, v13, v25
  v_lshrrev_b32 v12, 1, v12
  v_cmp_eq_u32 vcc, 0, v12
  s_nop 1
  v_cndmask_b32 v25, 0, v13, vcc
  v_cmp_eq_u32 vcc, 1, v12
  s_nop 1
  v_cndmask_b32 v26, 0, v13, vcc
  v_cmp_eq_u32 vcc, 2, v12
  s_nop 1
  v_cndmask_b32 v27, 0, v13, vcc
  v_cmp_eq_u32 vcc, 3, v12
  s_nop 1
  v_cndmask_b32 v28, 0, v13, vcc
  v_and_b32 v32, v16, v25
  v_and_b32 v33, v16, v26
  v_and_b32 v34, v16, v27
  v_and_b32 v35, v16, v28
  s_waitcnt vmcnt(0)
  s_nop 1
  v_mfma_f32_16x16x32_bf16 v[56:59], v[32:35], v[92:95], 0
  v_mfma_f32_16x16x32_bf16 v[60:63], v[32:35], v[96:99], 0
  v_mfma_f32_16x16x32_bf16 v[64:67], v[32:35], v[100:103], 0
  v_mfma_f32_16x16x32_bf16 v[68:71], v[32:35], v[104:107], 0
  v_mfma_f32_16x16x32_bf16 v[72:75], v[32:35], v[108:111], 0
  v_mfma_f32_16x16x32_bf16 v[76:79], v[32:35], v[112:115], 0
  v_mfma_f32_16x16x32_bf16 v[80:83], v[32:35], v[116:119], 0
  v_mfma_f32_16x16x32_bf16 v[84:87], v[32:35], v[120:123], 0
  v_mfma_f32_16x16x32_bf16 v[88:91], v[32:35], v[124:127], 0
  v_lshrrev_b32 v12, 3, v3
  s_movk_i32 s7, 2304
  v_mul_lo_u32 v13, v12, s7
  v_and_b32 v14, 7, v3
  v_lshl_add_u32 v13, v14, 5, v13
  v_and_b32 v14, 1, v2
  v_lshl_add_u32 v13, v14, 4, v13
  s_mul_i32 s7, s8, 4608
  s_add_u32 s7, s7, 17408
  v_add_u32 v13, s7, v13
  v_lshrrev_b32 v14, 1, v2
  v_cmp_eq_u32 vcc, v12, v14
  s_nop 1
  s_and_saveexec_b64 s[84:85], vcc
  ds_write_b128 v13, v[56:59] offset:0
  ds_write_b128 v13, v[60:63] offset:256
  ds_write_b128 v13, v[64:67] offset:512
  ds_write_b128 v13, v[68:71] offset:768
  ds_write_b128 v13, v[72:75] offset:1024
  ds_write_b128 v13, v[76:79] offset:1280
  ds_write_b128 v13, v[80:83] offset:1536
  ds_write_b128 v13, v[84:87] offset:1792
  ds_write_b128 v13, v[88:91] offset:2048
  s_mov_b64 exec, s[84:85]
  v_mov_b32 v12, 45584
  v_mov_b32 v13, 1
  v_cmp_eq_u32 vcc, 0, v1
  s_and_saveexec_b64 s[84:85], vcc
  ds_add_u32 v12, v13
  s_mov_b64 exec, s[84:85]
  s_branch P2JOIN_23
P2RED_24:
  s_and_b32 s9, s2, 3
  s_cmp_eq_u32 s9, 0
  s_cbranch_scc1 RED3_33
  v_mov_b32 v12, 45584
  s_mov_b32 s90, 0
LW_35:
  ds_read_b32 v13, v12
  s_waitcnt lgkmcnt(0)
  v_readfirstlane_b32 s93, v13
  s_nop 0
  s_cmp_ge_u32 s93, 2
  s_cbranch_scc1 LWD_36
  s_add_u32 s90, s90, 1
  s_cmp_lt_u32 s90, 2000000
  s_cbranch_scc1 LW_35
LWD_36:
  s_sub_u32 s6, s3, 5
  s_lshl_b32 s6, s6, 6
  v_add_u32 v12, s6, v1
  v_cmp_gt_u32 vcc, 144, v12
  s_nop 1
  s_and_saveexec_b64 s[84:85], vcc
  s_cbranch_execz REDSK_37
  v_lshlrev_b32 v13, 4, v12
  v_add_u32 v13, 17408, v13
  ds_read_b128 v[56:59], v13 offset:0
  ds_read_b128 v[60:63], v13 offset:2304
  ds_read_b128 v[64:67], v13 offset:4608
  ds_read_b128 v[68:71], v13 offset:6912
  s_waitcnt lgkmcnt(0)
  v_add_f32 v56, v56, v60
  v_add_f32 v57, v57, v61
  v_add_f32 v58, v58, v62
  v_add_f32 v59, v59, v63
  v_add_f32 v56, v56, v64
  v_add_f32 v57, v57, v65
  v_add_f32 v58, v58, v66
  v_add_f32 v59, v59, v67
  v_add_f32 v56, v56, v68
  v_add_f32 v57, v57, v69
  v_add_f32 v58, v58, v70
  v_add_f32 v59, v59, v71
  v_lshrrev_b32 v13, 1, v12
  v_lshlrev_b32 v13, 14, v13
  v_and_b32 v14, 1, v12
  v_lshl_add_u32 v13, v14, 4, v13
  s_lshl_b32 s6, s2, 6
  s_add_u32 s6, s6, 1179680
  v_bfi_b32 v56, v29, v7, v56
  v_bfi_b32 v57, v29, v7, v57
  v_bfi_b32 v58, v29, v7, v58
  v_bfi_b32 v59, v29, v7, v59
  buffer_store_dwordx4 v[56:59], v13, s[80:83], s6 offen sc1
REDSK_37:
  s_mov_b64 exec, s[84:85]
  s_branch REDJ_34
RED3_33:
  v_mov_b32 v12, 45584
  s_mov_b32 s90, 0
LW_38:
  ds_read_b32 v13, v12
  s_waitcnt lgkmcnt(0)
  v_readfirstlane_b32 s93, v13
  s_nop 0
  s_cmp_ge_u32 s93, 3
  s_cbranch_scc1 LWD_39
  s_add_u32 s90, s90, 1
  s_cmp_lt_u32 s90, 2000000
  s_cbranch_scc1 LW_38
LWD_39:
  s_sub_u32 s6, s3, 5
  s_lshl_b32 s6, s6, 6
  v_add_u32 v12, s6, v1
  v_cmp_gt_u32 vcc, 144, v12
  s_nop 1
  s_and_saveexec_b64 s[84:85], vcc
  s_cbranch_execz REDSK_40
  v_lshlrev_b32 v13, 4, v12
  v_add_u32 v13, 17408, v13
  ds_read_b128 v[56:59], v13 offset:0
  ds_read_b128 v[60:63], v13 offset:2304
  ds_read_b128 v[64:67], v13 offset:4608
  ds_read_b128 v[68:71], v13 offset:6912
  ds_read_b128 v[72:75], v13 offset:9216
  ds_read_b128 v[76:79], v13 offset:11520
  s_waitcnt lgkmcnt(0)
  v_add_f32 v56, v56, v60
  v_add_f32 v57, v57, v61
  v_add_f32 v58, v58, v62
  v_add_f32 v59, v59, v63
  v_add_f32 v56, v56, v64
  v_add_f32 v57, v57, v65
  v_add_f32 v58, v58, v66
  v_add_f32 v59, v59, v67
  v_add_f32 v56, v56, v68
  v_add_f32 v57, v57, v69
  v_add_f32 v58, v58, v70
  v_add_f32 v59, v59, v71
  v_add_f32 v56, v56, v72
  v_add_f32 v57, v57, v73
  v_add_f32 v58, v58, v74
  v_add_f32 v59, v59, v75
  v_add_f32 v56, v56, v76
  v_add_f32 v57, v57, v77
  v_add_f32 v58, v58, v78
  v_add_f32 v59, v59, v79
  v_lshrrev_b32 v13, 1, v12
  v_lshlrev_b32 v13, 14, v13
  v_and_b32 v14, 1, v12
  v_lshl_add_u32 v13, v14, 4, v13
  s_lshl_b32 s6, s2, 6
  s_add_u32 s6, s6, 1179680
  v_bfi_b32 v56, v29, v7, v56
  v_bfi_b32 v57, v29, v7, v57
  v_bfi_b32 v58, v29, v7, v58
  v_bfi_b32 v59, v29, v7, v59
  buffer_store_dwordx4 v[56:59], v13, s[80:83], s6 offen sc1
REDSK_40:
  s_mov_b64 exec, s[84:85]
REDJ_34:
  v_mov_b32 v12, 45588
  s_mov_b32 s90, 0
LW_41:
  ds_read_b32 v13, v12
  s_waitcnt lgkmcnt(0)
  v_readfirstlane_b32 s93, v13
  s_nop 0
  s_cmp_ge_u32 s93, 2
  s_cbranch_scc1 LWD_42
  s_add_u32 s90, s90, 1
  s_cmp_lt_u32 s90, 2000000
  s_cbranch_scc1 LW_41
LWD_42:
  s_sub_u32 s6, s3, 5
  s_lshl_b32 s6, s6, 6
  v_add_u32 v12, s6, v1
  v_cmp_gt_u32 vcc, 144, v12
  s_nop 1
  s_and_saveexec_b64 s[84:85], vcc
  s_cbranch_execz REDSK_43
  v_lshlrev_b32 v13, 4, v12
  v_add_u32 v13, 35840, v13
  ds_read_b128 v[56:59], v13 offset:0
  ds_read_b128 v[60:63], v13 offset:2304
  ds_read_b128 v[64:67], v13 offset:4608
  ds_read_b128 v[68:71], v13 offset:6912
  s_waitcnt lgkmcnt(0)
  v_add_f32 v56, v56, v60
  v_add_f32 v57, v57, v61
  v_add_f32 v58, v58, v62
  v_add_f32 v59, v59, v63
  v_add_f32 v56, v56, v64
  v_add_f32 v57, v57, v65
  v_add_f32 v58, v58, v66
  v_add_f32 v59, v59, v67
  v_add_f32 v56, v56, v68
  v_add_f32 v57, v57, v69
  v_add_f32 v58, v58, v70
  v_add_f32 v59, v59, v71
  v_lshrrev_b32 v13, 1, v12
  v_lshlrev_b32 v13, 14, v13
  v_and_b32 v14, 1, v12
  v_lshl_add_u32 v13, v14, 4, v13
  s_lshl_b32 s6, s2, 6
  s_add_u32 s6, s6, 1179648
  v_bfi_b32 v56, v29, v7, v56
  v_bfi_b32 v57, v29, v7, v57
  v_bfi_b32 v58, v29, v7, v58
  v_bfi_b32 v59, v29, v7, v59
  buffer_store_dwordx4 v[56:59], v13, s[80:83], s6 offen sc1
REDSK_43:
  s_mov_b64 exec, s[84:85]
P2JOIN_23:
  s_cmp_ge_u32 s2, 72
  s_cbranch_scc1 NOFIN_44
  s_lshl_b32 s6, s3, 6
  v_add_u32 v12, s6, v1
  v_lshrrev_b32 v14, 1, v12
  v_lshlrev_b32 v14, 6, v14
  v_and_b32 v13, 1, v12
  v_lshl_add_u32 v14, v13, 4, v14
  s_lshl_b32 s6, s2, 14
  s_add_u32 s6, s6, 1179648
  s_mov_b64 s[84:85], exec
  s_mov_b32 s90, 0
POLL_45:
  buffer_load_dwordx4 v[48:51], v14, s[80:83], s6 offen offset:0 sc1
  buffer_load_dwordx4 v[52:55], v14, s[80:83], s6 offen offset:32 sc1
  s_waitcnt vmcnt(0)
  v_xor_b32 v12, v48, v7
  v_xor_b32 v13, v49, v7
  v_or_b32 v12, v12, v13
  v_xor_b32 v13, v50, v7
  v_or_b32 v12, v12, v13
  v_xor_b32 v13, v51, v7
  v_or_b32 v12, v12, v13
  v_xor_b32 v13, v52, v7
  v_or_b32 v12, v12, v13
  v_xor_b32 v13, v53, v7
  v_or_b32 v12, v12, v13
  v_xor_b32 v13, v54, v7
  v_or_b32 v12, v12, v13
  v_xor_b32 v13, v55, v7
  v_or_b32 v12, v12, v13
  v_and_b32 v12, 4095, v12
  v_cmp_ne_u32 vcc, 0, v12
  s_nop 1
  s_and_b64 vcc, vcc, exec
  s_cmp_eq_u64 vcc, 0
  s_cbranch_scc1 PDONE_46
  s_add_u32 s90, s90, 1
  s_cmp_gt_u32 s90, 20000
  s_cbranch_scc1 PDONE_46
  s_mov_b64 exec, vcc
  s_branch POLL_45
PDONE_46:
  s_mov_b64 exec, s[84:85]
  s_nop 0
  v_and_b32 v48, 0xfffff000, v48
  v_and_b32 v49, 0xfffff000, v49
  v_and_b32 v50, 0xfffff000, v50
  v_and_b32 v51, 0xfffff000, v51
  v_and_b32 v52, 0xfffff000, v52
  v_and_b32 v53, 0xfffff000, v53
  v_and_b32 v54, 0xfffff000, v54
  v_and_b32 v55, 0xfffff000, v55
  s_nop 1
  v_add_f32_dpp v48, v48, v48 row_ror:2 row_mask:0xf bank_mask:0xf
  s_nop 1
  v_add_f32_dpp v48, v48, v48 row_ror:4 row_mask:0xf bank_mask:0xf
  s_nop 1
  v_add_f32_dpp v48, v48, v48 row_ror:8 row_mask:0xf bank_mask:0xf
  v_mov_b32 v12, v48
  s_nop 1
  v_permlane16_swap_b32 v48, v12
  s_nop 0
  v_add_f32 v48, v48, v12
  v_mov_b32 v12, v48
  s_nop 1
  v_permlane32_swap_b32 v48, v12
  s_nop 0
  v_add_f32 v48, v48, v12
  s_nop 1
  v_add_f32_dpp v49, v49, v49 row_ror:2 row_mask:0xf bank_mask:0xf
  s_nop 1
  v_add_f32_dpp v49, v49, v49 row_ror:4 row_mask:0xf bank_mask:0xf
  s_nop 1
  v_add_f32_dpp v49, v49, v49 row_ror:8 row_mask:0xf bank_mask:0xf
  v_mov_b32 v12, v49
  s_nop 1
  v_permlane16_swap_b32 v49, v12
  s_nop 0
  v_add_f32 v49, v49, v12
  v_mov_b32 v12, v49
  s_nop 1
  v_permlane32_swap_b32 v49, v12
  s_nop 0
  v_add_f32 v49, v49, v12
  s_nop 1
  v_add_f32_dpp v50, v50, v50 row_ror:2 row_mask:0xf bank_mask:0xf
  s_nop 1
  v_add_f32_dpp v50, v50, v50 row_ror:4 row_mask:0xf bank_mask:0xf
  s_nop 1
  v_add_f32_dpp v50, v50, v50 row_ror:8 row_mask:0xf bank_mask:0xf
  v_mov_b32 v12, v50
  s_nop 1
  v_permlane16_swap_b32 v50, v12
  s_nop 0
  v_add_f32 v50, v50, v12
  v_mov_b32 v12, v50
  s_nop 1
  v_permlane32_swap_b32 v50, v12
  s_nop 0
  v_add_f32 v50, v50, v12
  s_nop 1
  v_add_f32_dpp v51, v51, v51 row_ror:2 row_mask:0xf bank_mask:0xf
  s_nop 1
  v_add_f32_dpp v51, v51, v51 row_ror:4 row_mask:0xf bank_mask:0xf
  s_nop 1
  v_add_f32_dpp v51, v51, v51 row_ror:8 row_mask:0xf bank_mask:0xf
  v_mov_b32 v12, v51
  s_nop 1
  v_permlane16_swap_b32 v51, v12
  s_nop 0
  v_add_f32 v51, v51, v12
  v_mov_b32 v12, v51
  s_nop 1
  v_permlane32_swap_b32 v51, v12
  s_nop 0
  v_add_f32 v51, v51, v12
  s_nop 1
  v_add_f32_dpp v52, v52, v52 row_ror:2 row_mask:0xf bank_mask:0xf
  s_nop 1
  v_add_f32_dpp v52, v52, v52 row_ror:4 row_mask:0xf bank_mask:0xf
  s_nop 1
  v_add_f32_dpp v52, v52, v52 row_ror:8 row_mask:0xf bank_mask:0xf
  v_mov_b32 v12, v52
  s_nop 1
  v_permlane16_swap_b32 v52, v12
  s_nop 0
  v_add_f32 v52, v52, v12
  v_mov_b32 v12, v52
  s_nop 1
  v_permlane32_swap_b32 v52, v12
  s_nop 0
  v_add_f32 v52, v52, v12
  s_nop 1
  v_add_f32_dpp v53, v53, v53 row_ror:2 row_mask:0xf bank_mask:0xf
  s_nop 1
  v_add_f32_dpp v53, v53, v53 row_ror:4 row_mask:0xf bank_mask:0xf
  s_nop 1
  v_add_f32_dpp v53, v53, v53 row_ror:8 row_mask:0xf bank_mask:0xf
  v_mov_b32 v12, v53
  s_nop 1
  v_permlane16_swap_b32 v53, v12
  s_nop 0
  v_add_f32 v53, v53, v12
  v_mov_b32 v12, v53
  s_nop 1
  v_permlane32_swap_b32 v53, v12
  s_nop 0
  v_add_f32 v53, v53, v12
  s_nop 1
  v_add_f32_dpp v54, v54, v54 row_ror:2 row_mask:0xf bank_mask:0xf
  s_nop 1
  v_add_f32_dpp v54, v54, v54 row_ror:4 row_mask:0xf bank_mask:0xf
  s_nop 1
  v_add_f32_dpp v54, v54, v54 row_ror:8 row_mask:0xf bank_mask:0xf
  v_mov_b32 v12, v54
  s_nop 1
  v_permlane16_swap_b32 v54, v12
  s_nop 0
  v_add_f32 v54, v54, v12
  v_mov_b32 v12, v54
  s_nop 1
  v_permlane32_swap_b32 v54, v12
  s_nop 0
  v_add_f32 v54, v54, v12
  s_nop 1
  v_add_f32_dpp v55, v55, v55 row_ror:2 row_mask:0xf bank_mask:0xf
  s_nop 1
  v_add_f32_dpp v55, v55, v55 row_ror:4 row_mask:0xf bank_mask:0xf
  s_nop 1
  v_add_f32_dpp v55, v55, v55 row_ror:8 row_mask:0xf bank_mask:0xf
  v_mov_b32 v12, v55
  s_nop 1
  v_permlane16_swap_b32 v55, v12
  s_nop 0
  v_add_f32 v55, v55, v12
  v_mov_b32 v12, v55
  s_nop 1
  v_permlane32_swap_b32 v55, v12
  s_nop 0
  v_add_f32 v55, v55, v12
  s_lshl_b32 s6, s3, 6
  s_add_u32 s6, s6, 45056
  v_lshl_add_u32 v12, v1, 5, s6
  v_cmp_gt_u32 vcc, 2, v1
  s_nop 1
  s_and_saveexec_b64 s[84:85], vcc
  ds_write_b128 v12, v[48:51]
  ds_write_b128 v12, v[52:55] offset:16
  s_mov_b64 exec, s[84:85]
  v_mov_b32 v12, 45592
  v_mov_b32 v13, 1
  v_cmp_eq_u32 vcc, 0, v1
  s_and_saveexec_b64 s[84:85], vcc
  ds_add_u32 v12, v13
  s_mov_b64 exec, s[84:85]
  s_cmp_lg_u32 s3, 0
  s_cbranch_scc1 FINW0_47
  v_lshlrev_b32 v10, 1, v1
  s_lshl_b32 s8, s2, 4
  buffer_load_ushort v9, v10, s[40:43], s8 offen
  v_mov_b32 v12, 45592
  s_mov_b32 s90, 0
LW_48:
  ds_read_b32 v13, v12
  s_waitcnt lgkmcnt(0)
  v_readfirstlane_b32 s93, v13
  s_nop 0
  s_cmp_ge_u32 s93, 8
  s_cbranch_scc1 LWD_49
  s_add_u32 s90, s90, 1
  s_cmp_lt_u32 s90, 2000000
  s_cbranch_scc1 LW_48
LWD_49:
  v_lshrrev_b32 v12, 2, v1
  v_lshlrev_b32 v12, 5, v12
  v_and_b32 v13, 3, v1
  v_lshl_add_u32 v12, v13, 2, v12
  v_add_u32 v12, 45056, v12
  v_cmp_gt_u32 vcc, 8, v1
  s_nop 1
  s_and_saveexec_b64 s[84:85], vcc
  ds_read_b32 v48, v12 offset:0
  ds_read_b32 v56, v12 offset:16
  ds_read_b32 v49, v12 offset:64
  ds_read_b32 v57, v12 offset:80
  ds_read_b32 v50, v12 offset:128
  ds_read_b32 v58, v12 offset:144
  ds_read_b32 v51, v12 offset:192
  ds_read_b32 v59, v12 offset:208
  ds_read_b32 v52, v12 offset:256
  ds_read_b32 v60, v12 offset:272
  ds_read_b32 v53, v12 offset:320
  ds_read_b32 v61, v12 offset:336
  ds_read_b32 v54, v12 offset:384
  ds_read_b32 v62, v12 offset:400
  ds_read_b32 v55, v12 offset:448
  ds_read_b32 v63, v12 offset:464
  s_waitcnt vmcnt(0) lgkmcnt(0)
  v_add_f32 v48, v48, v49
  v_add_f32 v56, v56, v57
  v_add_f32 v48, v48, v50
  v_add_f32 v56, v56, v58
  v_add_f32 v48, v48, v51
  v_add_f32 v56, v56, v59
  v_add_f32 v48, v48, v52
  v_add_f32 v56, v56, v60
  v_add_f32 v48, v48, v53
  v_add_f32 v56, v56, v61
  v_add_f32 v48, v48, v54
  v_add_f32 v56, v56, v62
  v_add_f32 v48, v48, v55
  v_add_f32 v56, v56, v63
  v_cvt_pk_bf16_f32 v12, v48, v48
  v_lshlrev_b32 v48, 16, v12
  v_cvt_pk_bf16_f32 v12, v56, v56
  v_lshlrev_b32 v56, 16, v12
  v_mul_f32 v12, 0xbfb8aa3b, v56
  v_exp_f32 v12, v12
  s_nop 0
  v_add_f32 v12, 1.0, v12
  v_rcp_f32 v12, v12
  s_nop 0
  v_mul_f32 v56, v56, v12
  v_cvt_pk_bf16_f32 v12, v56, v56
  v_lshlrev_b32 v56, 16, v12
  v_mul_f32 v48, v48, v56
  v_cvt_pk_bf16_f32 v12, v48, v48
  v_lshlrev_b32 v48, 16, v12
  v_lshlrev_b32 v9, 16, v9
  v_add_f32 v48, v48, v9
  v_cvt_pk_bf16_f32 v48, v48, v48
  buffer_store_short v48, v10, s[72:75], s8 offen
  s_mov_b64 exec, s[84:85]
  s_cmp_lg_u32 s2, 0
  s_cbranch_scc1 NOEPOCH_50
  s_add_u32 s6, s96, 1
  v_mov_b32 v12, s6
  v_mov_b32 v13, 0
  s_mov_b32 s7, 2424832
  v_cmp_eq_u32 vcc, 0, v1
  s_and_saveexec_b64 s[84:85], vcc
  buffer_store_dword v12, v13, s[80:83], s7 offen
  s_mov_b64 exec, s[84:85]
NOEPOCH_50:
FINW0_47:
NOFIN_44:
  s_branch L_EXIT
L_AWAVE:
  s_mov_b32 s44, s18
  s_and_b32 s45, s19, 0xffff
  s_mov_b32 s46, 67108864
  s_mov_b32 s47, 0x00020000
  s_mov_b32 s48, s20
  s_and_b32 s49, s21, 0xffff
  s_mov_b32 s50, 67108864
  s_mov_b32 s51, 0x00020000
  s_sub_u32 s6, s3, 8
  s_lshl_b32 s7, s4, 22
  s_lshl_b32 s8, s5, 16
  s_add_u32 s7, s7, s8
  s_lshl_b32 s8, s6, 13
  s_add_u32 s7, s7, s8
  s_add_u32 s7, s7, 0x300000
  s_add_u32 s8, s7, 4096
  v_and_b32 v4, 3, v3
  v_lshlrev_b32 v4, 2, v4
  v_lshrrev_b32 v5, 2, v3
  v_add_u32 v4, v4, v5
  v_lshlrev_b32 v4, 8, v4
  v_lshlrev_b32 v5, 4, v2
  v_add_u32 v4, v4, v5
  v_lshlrev_b32 v5, 4, v1
  s_and_b32 s9, s2, 7
  v_and_b32 v8, 3, v3
  v_lshlrev_b32 v8, 2, v8
  v_lshrrev_b32 v9, 2, v3
  v_add_u32 v8, v8, v9
  s_lshl_b32 s10, s9, 2
  v_add_u32 v8, s10, v8
  v_add_u32 v9, 16, v8
  v_and_b32 v8, 31, v8
  v_and_b32 v9, 31, v9
  v_lshlrev_b32 v10, 4, v2
  v_lshl_add_u32 v4, v8, 8, v10
  v_lshl_add_u32 v6, v9, 8, v10
  v_mov_b32 v12, 45596
  s_mov_b32 s90, 0
LW_51:
  ds_read_b32 v13, v12
  s_waitcnt lgkmcnt(0)
  v_readfirstlane_b32 s93, v13
  s_nop 0
  s_cmp_ge_u32 s93, 8
  s_cbranch_scc1 LWD_52
  s_add_u32 s90, s90, 1
  s_cmp_lt_u32 s90, 2000000
  s_cbranch_scc1 LW_51
LWD_52:
  buffer_load_dwordx4 v[32:35], v4, s[44:47], s7 offen offset:0 nt
  buffer_load_dwordx4 v[36:39], v4, s[44:47], s7 offen offset:64 nt
  buffer_load_dwordx4 v[40:43], v4, s[44:47], s7 offen offset:128 nt
  buffer_load_dwordx4 v[44:47], v4, s[44:47], s7 offen offset:192 nt
  buffer_load_dwordx4 v[48:51], v6, s[44:47], s7 offen offset:0 nt
  buffer_load_dwordx4 v[52:55], v6, s[44:47], s7 offen offset:64 nt
  buffer_load_dwordx4 v[56:59], v6, s[44:47], s7 offen offset:128 nt
  buffer_load_dwordx4 v[60:63], v6, s[44:47], s7 offen offset:192 nt
  s_add_u32 s10, s9, 0
  s_and_b32 s10, s10, 7
  s_lshl_b32 s10, s10, 10
  s_add_u32 s10, s10, s7
  buffer_load_dwordx4 v[64:67], v5, s[48:51], s10 offen nt
  s_add_u32 s10, s9, 1
  s_and_b32 s10, s10, 7
  s_lshl_b32 s10, s10, 10
  s_add_u32 s10, s10, s7
  buffer_load_dwordx4 v[68:71], v5, s[48:51], s10 offen nt
  s_add_u32 s10, s9, 2
  s_and_b32 s10, s10, 7
  s_lshl_b32 s10, s10, 10
  s_add_u32 s10, s10, s7
  buffer_load_dwordx4 v[72:75], v5, s[48:51], s10 offen nt
  s_add_u32 s10, s9, 3
  s_and_b32 s10, s10, 7
  s_lshl_b32 s10, s10, 10
  s_add_u32 s10, s10, s7
  buffer_load_dwordx4 v[76:79], v5, s[48:51], s10 offen nt
  s_add_u32 s10, s9, 4
  s_and_b32 s10, s10, 7
  s_lshl_b32 s10, s10, 10
  s_add_u32 s10, s10, s7
  buffer_load_dwordx4 v[80:83], v5, s[48:51], s10 offen nt
  s_add_u32 s10, s9, 5
  s_and_b32 s10, s10, 7
  s_lshl_b32 s10, s10, 10
  s_add_u32 s10, s10, s7
  buffer_load_dwordx4 v[84:87], v5, s[48:51], s10 offen nt
  s_add_u32 s10, s9, 6
  s_and_b32 s10, s10, 7
  s_lshl_b32 s10, s10, 10
  s_add_u32 s10, s10, s7
  buffer_load_dwordx4 v[88:91], v5, s[48:51], s10 offen nt
  s_add_u32 s10, s9, 7
  s_and_b32 s10, s10, 7
  s_lshl_b32 s10, s10, 10
  s_add_u32 s10, s10, s7
  buffer_load_dwordx4 v[92:95], v5, s[48:51], s10 offen nt
  v_mov_b32 v12, 45572
  v_mov_b32 v13, 1
  v_cmp_eq_u32 vcc, 0, v1
  s_and_saveexec_b64 s[84:85], vcc
  ds_add_u32 v12, v13
  s_mov_b64 exec, s[84:85]
  v_and_b32 v8, 7, v1
  v_and_b32 v9, 1, v1
  v_lshlrev_b32 v9, 4, v9
  v_mov_b32 v120, 0xffff
  v_lshlrev_b32 v9, v9, v120
  v_lshrrev_b32 v8, 1, v8
  v_cmp_eq_u32 vcc, 0, v8
  s_nop 1
  v_cndmask_b32 v120, 0, v9, vcc
  v_cmp_eq_u32 vcc, 1, v8
  s_nop 1
  v_cndmask_b32 v121, 0, v9, vcc
  v_cmp_eq_u32 vcc, 2, v8
  s_nop 1
  v_cndmask_b32 v122, 0, v9, vcc
  v_cmp_eq_u32 vcc, 3, v8
  s_nop 1
  v_cndmask_b32 v123, 0, v9, vcc
  v_lshrrev_b32 v6, 3, v1
  v_and_b32 v6, 1, v6
  v_lshlrev_b32 v6, 8, v6
  v_lshl_add_u32 v6, v2, 4, v6
  v_add_u32 v6, 8192, v6
  v_mov_b32 v12, 45576
  s_mov_b32 s90, 0
LW_53:
  ds_read_b32 v13, v12
  s_waitcnt lgkmcnt(0)
  v_readfirstlane_b32 s93, v13
  s_nop 0
  s_cmp_ge_u32 s93, 4
  s_cbranch_scc1 LWD_54
  s_add_u32 s90, s90, 1
  s_cmp_lt_u32 s90, 2000000
  s_cbranch_scc1 LW_53
LWD_54:
  ds_read_b128 v[96:99], v6 offset:0
  ds_read_b128 v[100:103], v6 offset:64
  ds_read_b128 v[104:107], v6 offset:128
  ds_read_b128 v[108:111], v6 offset:192
  s_waitcnt vmcnt(8) lgkmcnt(0)
  v_mfma_f32_16x16x32_bf16 v[112:115], v[32:35], v[96:99], 0
  v_mfma_f32_16x16x32_bf16 v[116:119], v[48:51], v[96:99], 0
  v_mfma_f32_16x16x32_bf16 v[112:115], v[36:39], v[100:103], v[112:115]
  v_mfma_f32_16x16x32_bf16 v[116:119], v[52:55], v[100:103], v[116:119]
  v_mfma_f32_16x16x32_bf16 v[112:115], v[40:43], v[104:107], v[112:115]
  v_mfma_f32_16x16x32_bf16 v[116:119], v[56:59], v[104:107], v[116:119]
  v_mfma_f32_16x16x32_bf16 v[112:115], v[44:47], v[108:111], v[112:115]
  v_mfma_f32_16x16x32_bf16 v[116:119], v[60:63], v[108:111], v[116:119]
  s_nop 7
  v_cvt_pk_bf16_f32 v8, v112, v113
  v_lshlrev_b32 v112, 16, v8
  v_and_b32 v113, 0xffff0000, v8
  v_mul_f32 v112, s91, v112
  v_mul_f32 v113, s91, v113
  v_cvt_pk_bf16_f32 v8, v112, v113
  v_lshlrev_b32 v112, 16, v8
  v_and_b32 v113, 0xffff0000, v8
  v_cvt_pk_bf16_f32 v8, v114, v115
  v_lshlrev_b32 v114, 16, v8
  v_and_b32 v115, 0xffff0000, v8
  v_mul_f32 v114, s91, v114
  v_mul_f32 v115, s91, v115
  v_cvt_pk_bf16_f32 v8, v114, v115
  v_lshlrev_b32 v114, 16, v8
  v_and_b32 v115, 0xffff0000, v8
  v_cvt_pk_bf16_f32 v8, v116, v117
  v_lshlrev_b32 v116, 16, v8
  v_and_b32 v117, 0xffff0000, v8
  v_mul_f32 v116, s91, v116
  v_mul_f32 v117, s91, v117
  v_cvt_pk_bf16_f32 v8, v116, v117
  v_lshlrev_b32 v116, 16, v8
  v_and_b32 v117, 0xffff0000, v8
  v_cvt_pk_bf16_f32 v8, v118, v119
  v_lshlrev_b32 v118, 16, v8
  v_and_b32 v119, 0xffff0000, v8
  v_mul_f32 v118, s91, v118
  v_mul_f32 v119, s91, v119
  v_cvt_pk_bf16_f32 v8, v118, v119
  v_lshlrev_b32 v118, 16, v8
  v_and_b32 v119, 0xffff0000, v8
  v_max3_f32 v12, v112, v113, v114
  v_max3_f32 v12, v12, v115, v116
  v_max3_f32 v12, v12, v117, v118
  v_max_f32 v12, v12, v119
  v_mov_b32 v9, v12
  s_nop 1
  v_permlane16_swap_b32 v12, v9
  s_nop 0
  v_max_f32 v12, v12, v9
  v_mov_b32 v9, v12
  s_nop 1
  v_permlane32_swap_b32 v12, v9
  s_nop 0
  v_max_f32 v12, v12, v9
  v_mul_f32 v10, s92, v12
  v_fma_f32 v112, v112, s92, -v10
  v_fma_f32 v113, v113, s92, -v10
  v_fma_f32 v114, v114, s92, -v10
  v_fma_f32 v115, v115, s92, -v10
  v_fma_f32 v116, v116, s92, -v10
  v_fma_f32 v117, v117, s92, -v10
  v_fma_f32 v118, v118, s92, -v10
  v_fma_f32 v119, v119, s92, -v10
  v_exp_f32 v112, v112
  v_exp_f32 v113, v113
  v_exp_f32 v114, v114
  v_exp_f32 v115, v115
  v_exp_f32 v116, v116
  v_exp_f32 v117, v117
  v_exp_f32 v118, v118
  v_exp_f32 v119, v119
  s_nop 0
  v_add_f32 v13, v112, v113
  v_add_f32 v13, v13, v114
  v_add_f32 v13, v13, v115
  v_add_f32 v13, v13, v116
  v_add_f32 v13, v13, v117
  v_add_f32 v13, v13, v118
  v_add_f32 v13, v13, v119
  v_mov_b32 v9, v13
  s_nop 1
  v_permlane16_swap_b32 v13, v9
  s_nop 0
  v_add_f32 v13, v13, v9
  v_mov_b32 v9, v13
  s_nop 1
  v_permlane32_swap_b32 v13, v9
  s_nop 0
  v_add_f32 v13, v13, v9
  v_cvt_pk_bf16_f32 v112, v112, v112
  v_cvt_pk_bf16_f32 v113, v113, v113
  v_cvt_pk_bf16_f32 v114, v114, v114
  v_cvt_pk_bf16_f32 v115, v115, v115
  v_cvt_pk_bf16_f32 v116, v116, v116
  v_cvt_pk_bf16_f32 v117, v117, v117
  v_cvt_pk_bf16_f32 v118, v118, v118
  v_cvt_pk_bf16_f32 v119, v119, v119
  s_waitcnt vmcnt(0)
  v_and_b32 v16, v112, v120
  v_and_b32 v17, v112, v121
  v_and_b32 v18, v112, v122
  v_and_b32 v19, v112, v123
  v_and_b32 v20, v113, v120
  v_and_b32 v21, v113, v121
  v_and_b32 v22, v113, v122
  v_and_b32 v23, v113, v123
  v_mfma_f32_16x16x32_bf16 v[124:127], v[16:19], v[64:67], 0
  v_and_b32 v16, v114, v120
  v_and_b32 v17, v114, v121
  v_and_b32 v18, v114, v122
  v_and_b32 v19, v114, v123
  v_mfma_f32_16x16x32_bf16 v[124:127], v[20:23], v[68:71], v[124:127]
  v_and_b32 v20, v115, v120
  v_and_b32 v21, v115, v121
  v_and_b32 v22, v115, v122
  v_and_b32 v23, v115, v123
  v_mfma_f32_16x16x32_bf16 v[124:127], v[16:19], v[72:75], v[124:127]
  v_and_b32 v16, v116, v120
  v_and_b32 v17, v116, v121
  v_and_b32 v18, v116, v122
  v_and_b32 v19, v116, v123
  v_mfma_f32_16x16x32_bf16 v[124:127], v[20:23], v[76:79], v[124:127]
  v_and_b32 v20, v117, v120
  v_and_b32 v21, v117, v121
  v_and_b32 v22, v117, v122
  v_and_b32 v23, v117, v123
  v_mfma_f32_16x16x32_bf16 v[124:127], v[16:19], v[80:83], v[124:127]
  v_and_b32 v16, v118, v120
  v_and_b32 v17, v118, v121
  v_and_b32 v18, v118, v122
  v_and_b32 v19, v118, v123
  v_mfma_f32_16x16x32_bf16 v[124:127], v[20:23], v[84:87], v[124:127]
  v_and_b32 v20, v119, v120
  v_and_b32 v21, v119, v121
  v_and_b32 v22, v119, v122
  v_and_b32 v23, v119, v123
  v_mfma_f32_16x16x32_bf16 v[124:127], v[16:19], v[88:91], v[124:127]
  s_nop 1
  v_mfma_f32_16x16x32_bf16 v[124:127], v[20:23], v[92:95], v[124:127]
  v_lshrrev_b32 v8, 1, v2
  v_lshlrev_b32 v8, 9, v8
  v_lshl_add_u32 v8, v3, 5, v8
  v_and_b32 v9, 1, v2
  v_lshl_add_u32 v8, v9, 4, v8
  s_lshl_b32 s9, s6, 10
  s_add_u32 s9, s9, 9216
  v_add_u32 v8, s9, v8
  v_lshrrev_b32 v9, 3, v1
  v_and_b32 v9, 1, v9
  v_lshlrev_b32 v9, 3, v9
  s_lshl_b32 s9, s6, 4
  s_add_u32 s9, s9, 8960
  v_add_u32 v9, s9, v9
  ds_write_b64 v9, v[12:13]
  s_nop 3
  ds_write_b128 v8, v[124:127]
  v_mov_b32 v14, 45580
  v_mov_b32 v15, 1
  v_cmp_eq_u32 vcc, 0, v1
  s_and_saveexec_b64 s[84:85], vcc
  ds_add_u32 v14, v15
  s_mov_b64 exec, s[84:85]
  s_cmp_ge_u32 s6, 4
  s_cbranch_scc1 AEND_55
  s_add_u32 s97, s96, 1
  s_and_b32 s97, s97, 4095
  v_mov_b32 v28, 4095
  v_mov_b32 v29, s97
  s_lshr_b32 s9, s6, 1
  s_lshl_b32 s10, s9, 3
  s_add_u32 s10, s10, 8960
  v_mov_b32 v8, s10
  s_lshl_b32 s10, s6, 8
  v_lshl_add_u32 v7, v1, 2, s10
  v_add_u32 v9, 9216, v7
  v_mov_b32 v14, 45580
  s_mov_b32 s90, 0
LW_56:
  ds_read_b32 v15, v14
  s_waitcnt lgkmcnt(0)
  v_readfirstlane_b32 s93, v15
  s_nop 0
  s_cmp_ge_u32 s93, 8
  s_cbranch_scc1 LWD_57
  s_add_u32 s90, s90, 1
  s_cmp_lt_u32 s90, 2000000
  s_cbranch_scc1 LW_56
LWD_57:
  ds_read_b64 v[32:33], v8 offset:0
  ds_read_b64 v[34:35], v8 offset:16
  ds_read_b64 v[36:37], v8 offset:32
  ds_read_b64 v[38:39], v8 offset:48
  ds_read_b64 v[40:41], v8 offset:64
  ds_read_b64 v[42:43], v8 offset:80
  ds_read_b64 v[44:45], v8 offset:96
  ds_read_b64 v[46:47], v8 offset:112
  ds_read_b32 v48, v9 offset:0
  ds_read_b32 v49, v9 offset:1024
  ds_read_b32 v50, v9 offset:2048
  ds_read_b32 v51, v9 offset:3072
  ds_read_b32 v52, v9 offset:4096
  ds_read_b32 v53, v9 offset:5120
  ds_read_b32 v54, v9 offset:6144
  ds_read_b32 v55, v9 offset:7168
  s_waitcnt lgkmcnt(0)
  v_max3_f32 v10, v32, v34, v36
  v_max3_f32 v10, v10, v38, v40
  v_max3_f32 v10, v10, v42, v44
  v_max_f32 v10, v10, v46
  v_mul_f32 v11, s92, v10
  v_fma_f32 v32, v32, s92, -v11
  v_fma_f32 v34, v34, s92, -v11
  v_fma_f32 v36, v36, s92, -v11
  v_fma_f32 v38, v38, s92, -v11
  v_fma_f32 v40, v40, s92, -v11
  v_fma_f32 v42, v42, s92, -v11
  v_fma_f32 v44, v44, s92, -v11
  v_fma_f32 v46, v46, s92, -v11
  v_exp_f32 v32, v32
  v_exp_f32 v34, v34
  v_exp_f32 v36, v36
  v_exp_f32 v38, v38
  v_exp_f32 v40, v40
  v_exp_f32 v42, v42
  v_exp_f32 v44, v44
  v_exp_f32 v46, v46
  s_nop 0
  v_mul_f32 v11, v32, v33
  v_mul_f32 v12, v32, v48
  v_fmac_f32 v11, v34, v35
  v_fmac_f32 v12, v34, v49
  v_fmac_f32 v11, v36, v37
  v_fmac_f32 v12, v36, v50
  v_fmac_f32 v11, v38, v39
  v_fmac_f32 v12, v38, v51
  v_fmac_f32 v11, v40, v41
  v_fmac_f32 v12, v40, v52
  v_fmac_f32 v11, v42, v43
  v_fmac_f32 v12, v42, v53
  v_fmac_f32 v11, v44, v45
  v_fmac_f32 v12, v44, v54
  v_fmac_f32 v11, v46, v47
  v_fmac_f32 v12, v46, v55
  v_bfi_b32 v10, v28, v29, v10
  v_bfi_b32 v11, v28, v29, v11
  v_bfi_b32 v12, v28, v29, v12
  s_lshl_b32 s10, s2, 10
  s_add_u32 s10, s10, 851968
  buffer_store_dword v12, v7, s[80:83], s10 offen sc1
  s_and_b32 s11, s6, 1
  s_cmp_eq_u32 s11, 0
  s_cbranch_scc0 NOML_58
  s_lshl_b32 s10, s2, 1
  s_add_u32 s10, s10, s9
  s_lshl_b32 s10, s10, 4
  s_add_u32 s10, s10, 1114112
  v_mov_b32 v8, 0
  v_mov_b32 v12, v10
  v_mov_b32 v13, v11
  v_mov_b32 v14, v10
  v_mov_b32 v15, v11
  v_cmp_eq_u32 vcc, 0, v1
  s_and_saveexec_b64 s[84:85], vcc
  buffer_store_dwordx4 v[12:15], v8, s[80:83], s10 offen sc1
  s_mov_b64 exec, s[84:85]
NOML_58:
AEND_55:
  s_branch L_EXIT
L_EXIT:
  s_endpgm
.section .rodata,"a"
.p2align 6
.amdhsa_kernel recurrent_scan__sliding_block_cached__swiglu_ffn__decode_kernel
  .amdhsa_next_free_vgpr 128
  .amdhsa_next_free_sgpr 102
  .amdhsa_accum_offset 128
  .amdhsa_group_segment_fixed_size 0
  .amdhsa_kernarg_size 96
  .amdhsa_user_sgpr_count 2
  .amdhsa_user_sgpr_kernarg_segment_ptr 1
  .amdhsa_system_sgpr_workgroup_id_x 1
.end_amdhsa_kernel
```
